```python
import torch

def _softmax(x, axis=-1):
    return torch.softmax(x, dim=axis)
def _gelu(x):
    return torch.nn.functional.gelu(x, approximate="tanh")
def _silu(x):
    return torch.nn.functional.silu(x)
def _sigmoid(x):
    return torch.sigmoid(x)
def _layernorm(x, axis=-1, eps=1e-5):
    m = x.mean(dim=axis, keepdim=True)
    v = x.var(dim=axis, keepdim=True, unbiased=False)
    return (x - m) / torch.sqrt(v + eps)
def _scatter_add(tgt, idx, src, axis=0):
    return tgt.clone().index_add_(axis, idx, src)
def _segment_sum(src, seg, n):
    out = torch.zeros((n,) + src.shape[1:], dtype=src.dtype)
    return out.index_add_(0, seg, src)
def _pad(x, pw):
    flat = tuple(v for pair in reversed(pw) for v in pair)
    return torch.nn.functional.pad(x, flat)

kernel_name = 'concat_heads__grouped_kv_mqa__linear_kernel_hedgehog__prompt'

def setup_inputs():

    _w = (lambda a: (lambda t: t.to(torch.bfloat16) if t.is_floating_point() else t)(torch.as_tensor(a)))
    def _A_setup():
        B, S, D, H = 1, 2048, 512, 32
        Dh = D // H
        return {
            "x": _w((lambda *s: torch.randn(*s, dtype=torch.bfloat16) * 0.05)(B, S, D)),
            "wq": _w((lambda *s: torch.randn(*s, dtype=torch.bfloat16) * 1.6)(D, H * Dh)),
            "wk": _w((lambda *s: torch.randn(*s, dtype=torch.bfloat16) * 1.6)(D, Dh)),
            "wv": _w((lambda *s: torch.randn(*s, dtype=torch.bfloat16) * 1.6)(D, Dh)),
            "wo": _w((lambda *s: torch.randn(*s, dtype=torch.bfloat16) * 1.6)(H * Dh, D)),
        }
    _A_in = _A_setup()

    def _B_setup():
        B, S, D, H = 1, 2048, 512, 32
        Dh = D // H
        return {
            "x": _w((lambda *s: torch.randn(*s, dtype=torch.bfloat16) * 0.2)(B, S, D)),
            "wqkv": _w((lambda *s: torch.randn(*s, dtype=torch.bfloat16) * 1.6)(D, 3 * D)),
            "w_phi": _w((lambda *s: torch.randn(*s, dtype=torch.bfloat16) * 1.6)(H, Dh, Dh) * (Dh ** -0.5)),
            "wo": _w((lambda *s: torch.randn(*s, dtype=torch.bfloat16) * 0.8)(D, D)),
        }
    _B_in = _B_setup()

    return {
        "A_x": _A_in["x"],
        "A_wq": _A_in["wq"],
        "A_wk": _A_in["wk"],
        "A_wv": _A_in["wv"],
        "A_wo": _A_in["wo"],
        "B_x": _B_in["x"],
        "B_wqkv": _B_in["wqkv"],
        "B_w_phi": _B_in["w_phi"],
        "B_wo": _B_in["wo"],
    }

def reference(A_x, A_wq, A_wk, A_wv, A_wo, B_x, B_wqkv, B_w_phi, B_wo):
    def _A_ref(x, wq, wk, wv, wo):
        B, S, D = x.shape
        H = 32
        Dh = D // H
        q = (lambda x, *d: x.permute(*d))((x @ wq).reshape(B, S, H, Dh), 0, 2, 1, 3)
        k = x @ wk
        v = x @ wv
        scores = torch.einsum("bhqd,bkd->bhqk", q, k) * (Dh ** -0.5)
        p = _softmax(scores, axis=-1)
        o = torch.einsum("bhqk,bkd->bhqd", p, v)
        return (lambda x, *d: x.permute(*d))(o, 0, 2, 1, 3).reshape(B, S, H * Dh) @ wo

    def _B_ref(x, wqkv, w_phi, wo):
        B, S, D = x.shape
        H = 32; Dh = D // H
        qkv = (lambda x, *d: x.permute(*d))((x @ wqkv).reshape(B, S, 3, H, Dh), 2, 0, 3, 1, 4)
        q, k, v = qkv[0], qkv[1], qkv[2]
        pq = torch.einsum("bhsd,hdf->bhsf", q, w_phi)
        pk = torch.einsum("bhsd,hdf->bhsf", k, w_phi)
        phi_q = torch.concatenate([_softmax(pq, axis=-1), _softmax(-pq, axis=-1)], axis=-1)
        phi_k = torch.concatenate([_softmax(pk, axis=-1), _softmax(-pk, axis=-1)], axis=-1)
        kv = torch.einsum("bhsf,bhsd->bhfd", phi_k, v)
        z  = torch.einsum("bhsf->bhf", phi_k)
        num = torch.einsum("bhqf,bhfd->bhqd", phi_q, kv)
        den = torch.einsum("bhqf,bhf->bhq", phi_q, z)[..., None] + 1e-6
        o = num / den
        return (lambda x, *d: x.permute(*d))(o, 0, 2, 1, 3).reshape(B, S, D) @ wo

    a = _A_ref(A_x, A_wq, A_wk, A_wv, A_wo)
    b = _B_ref(B_x, B_wqkv, B_w_phi, B_wo)
    return torch.concatenate([a, b], axis=-1)
```

```asm
; @launch grid=(256,1,1) block=(512,1,1) lds=163840
.amdgcn_target "amdgcn-amd-amdhsa--gfx950"
.text
.globl concat_heads__grouped_kv_mqa__linear_kernel_hedgehog__prompt_kernel
.p2align 8
.type concat_heads__grouped_kv_mqa__linear_kernel_hedgehog__prompt_kernel,@function
concat_heads__grouped_kv_mqa__linear_kernel_hedgehog__prompt_kernel:
  s_cmp_ge_u32 s2, 256
  s_cbranch_scc1 K_END
  s_load_dwordx8 s[4:11], s[0:1], 0
  s_load_dwordx4 s[12:15], s[0:1], 40
  s_load_dwordx2 s[16:17], s[0:1], 56
  s_load_dwordx4 s[76:79], s[0:1], 80
  v_lshrrev_b32 v1, 6, v0
  v_and_b32 v0, 63, v0
  s_and_b32 s20, s2, 7
  v_readfirstlane_b32 s67, v1
  s_and_b32 s21, s67, 3
  s_mov_b32 s97, 0
  s_lshr_b32 s22, s2, 3
  s_lshr_b32 s23, s20, 1
  s_and_b32 s24, s20, 1
  s_lshl_b32 s24, s24, 3
  s_lshr_b32 s25, s22, 2
  s_add_u32 s24, s24, s25
  s_and_b32 s25, s22, 3
  s_lshr_b32 s26, s21, 1
  s_and_b32 s27, s21, 1
  s_movk_i32 s28, 3072
  s_cmp_eq_u32 s23, 0
  s_cselect_b32 s28, 1024, s28
  s_lshl_b32 s29, s25, 8
  s_sub_u32 s32, s23, 2
  s_lshl_b32 s32, s32, 2
  s_add_u32 s32, s32, s25
  s_lshl_b32 s33, s32, 7
  s_add_u32 s33, s33, 1024
  s_cmp_ge_u32 s23, 2
  s_cselect_b32 s29, s33, s29
  s_cselect_b32 s30, 1024, 64
  s_cselect_b32 s31, 64, 128
  v_lshrrev_b32 v2, 4, v0
  v_and_b32 v3, 15, v0
  v_lshlrev_b32 v4, 2, v2
  v_xor_b32 v3, v3, v4
  v_and_b32 v4, 3, v3
  v_lshlrev_b32 v4, 4, v4
  v_bfe_u32 v5, v3, 2, 1
  v_mul_lo_u32 v5, v5, s30
  v_lshrrev_b32 v6, 3, v3
  v_mul_lo_u32 v6, v6, s31
  v_add3_u32 v4, v4, v5, v6
  s_lshl_b32 s34, s21, 4
  v_add_u32 v5, s34, v2
  v_mul_lo_u32 v5, v5, s28
  v_add3_u32 v10, v4, v5, s29
  v_lshrrev_b32 v3, 3, v0
  s_lshl_b32 s34, s21, 5
  s_lshl_b32 s35, s24, 7
  s_add_u32 s34, s34, s35
  v_add_u32 v3, s34, v3
  v_lshlrev_b32 v3, 10, v3
  v_and_b32 v4, 7, v0
  v_xor_b32 v4, v4, v2
  v_lshl_add_u32 v11, v4, 4, v3
  v_xor_b32 v12, 64, v11
  v_lshlrev_b32 v13, 4, v0
  s_waitcnt lgkmcnt(0)
  s_cmp_eq_u32 s23, 0
  s_cselect_b32 s40, s4, s12
  s_cselect_b32 s41, s5, s13
  s_mov_b32 s42, 0x200000
  s_mov_b32 s43, 0x00020000
  s_cselect_b32 s44, s6, s14
  s_cselect_b32 s45, s7, s15
  s_lshl_b32 s46, s28, 9
  s_mov_b32 s47, 0x00020000
  s_cmp_lt_u32 s21, 2
  s_cselect_b32 s48, s8, s10
  s_cselect_b32 s49, s9, s11
  s_mov_b32 s50, 16384
  s_mov_b32 s51, 0x00020000
  s_mov_b32 s52, s16
  s_mov_b32 s53, s17
  s_mov_b32 s54, 16384
  s_mov_b32 s55, 0x00020000
  s_mov_b32 s56, s78
  s_mov_b32 s57, s79
  s_mov_b32 s58, 16777216
  s_mov_b32 s59, 0x00020000
  s_mov_b32 s78, 256
  s_mov_b32 s79, 0x00020000
  s_and_b32 s74, s2, 7
  s_lshl_b32 s74, s74, 2
  s_bfe_u32 s75, s2, 0x20003
  s_add_u32 s74, s74, s75
  s_lshr_b32 s75, s2, 5
  s_and_b32 s3, s75, 7
  s_cmp_ge_u32 s67, 4
  s_cbranch_scc1 K1_LD
  s_lshl_b32 s36, s21, 12
  s_mov_b32 s37, 0
  s_lshl_b32 s38, s28, 2
  s_lshl_b32 s39, s28, 6
  s_lshl_b32 s60, s21, 10
  s_lshl_b32 s61, s27, 10
  s_cmp_ge_u32 s23, 2
  s_cbranch_scc1 K1_KV
  s_add_u32 s98, s3, 0
  s_and_b32 s98, s98, 7
  s_add_u32 m0, s36, 65536
  s_mul_i32 s37, s98, s39
  buffer_load_dwordx4 v10, s[44:47], s37 offen lds
  s_add_u32 m0, s36, 66560
  s_add_u32 s37, s37, s38
  buffer_load_dwordx4 v10, s[44:47], s37 offen lds
  s_add_u32 m0, s36, 67584
  s_add_u32 s37, s37, s38
  buffer_load_dwordx4 v10, s[44:47], s37 offen lds
  s_add_u32 m0, s36, 68608
  s_add_u32 s37, s37, s38
  buffer_load_dwordx4 v10, s[44:47], s37 offen lds
  s_add_u32 m0, s60, 131072
  s_lshl_b32 s62, s98, 11
  s_add_u32 s62, s62, s61
  buffer_load_dwordx4 v13, s[48:51], s62 offen lds
  s_add_u32 s98, s3, 1
  s_and_b32 s98, s98, 7
  s_add_u32 m0, s36, 81920
  s_mul_i32 s37, s98, s39
  buffer_load_dwordx4 v10, s[44:47], s37 offen lds
  s_add_u32 m0, s36, 82944
  s_add_u32 s37, s37, s38
  buffer_load_dwordx4 v10, s[44:47], s37 offen lds
  s_add_u32 m0, s36, 83968
  s_add_u32 s37, s37, s38
  buffer_load_dwordx4 v10, s[44:47], s37 offen lds
  s_add_u32 m0, s36, 84992
  s_add_u32 s37, s37, s38
  buffer_load_dwordx4 v10, s[44:47], s37 offen lds
  s_add_u32 m0, s60, 135168
  s_lshl_b32 s62, s98, 11
  s_add_u32 s62, s62, s61
  buffer_load_dwordx4 v13, s[48:51], s62 offen lds
  s_add_u32 s98, s3, 2
  s_and_b32 s98, s98, 7
  s_add_u32 m0, s36, 98304
  s_mul_i32 s37, s98, s39
  buffer_load_dwordx4 v10, s[44:47], s37 offen lds
  s_add_u32 m0, s36, 99328
  s_add_u32 s37, s37, s38
  buffer_load_dwordx4 v10, s[44:47], s37 offen lds
  s_add_u32 m0, s36, 100352
  s_add_u32 s37, s37, s38
  buffer_load_dwordx4 v10, s[44:47], s37 offen lds
  s_add_u32 m0, s36, 101376
  s_add_u32 s37, s37, s38
  buffer_load_dwordx4 v10, s[44:47], s37 offen lds
  s_add_u32 m0, s60, 139264
  s_lshl_b32 s62, s98, 11
  s_add_u32 s62, s62, s61
  buffer_load_dwordx4 v13, s[48:51], s62 offen lds
  s_add_u32 s98, s3, 3
  s_and_b32 s98, s98, 7
  s_add_u32 m0, s36, 114688
  s_mul_i32 s37, s98, s39
  buffer_load_dwordx4 v10, s[44:47], s37 offen lds
  s_add_u32 m0, s36, 115712
  s_add_u32 s37, s37, s38
  buffer_load_dwordx4 v10, s[44:47], s37 offen lds
  s_add_u32 m0, s36, 116736
  s_add_u32 s37, s37, s38
  buffer_load_dwordx4 v10, s[44:47], s37 offen lds
  s_add_u32 m0, s36, 117760
  s_add_u32 s37, s37, s38
  buffer_load_dwordx4 v10, s[44:47], s37 offen lds
  s_add_u32 m0, s60, 143360
  s_lshl_b32 s62, s98, 11
  s_add_u32 s62, s62, s61
  buffer_load_dwordx4 v13, s[48:51], s62 offen lds
  v_and_b32 v2, 31, v0
  v_lshrrev_b32 v3, 5, v0
  v_bfe_u32 v4, v0, 1, 3
  v_xor_b32 v4, v4, v3
  v_lshlrev_b32 v4, 4, v4
  v_lshl_add_u32 v4, v2, 7, v4
  s_lshl_b32 s34, s26, 13
  s_and_b32 s35, s25, 1
  s_lshl_b32 s35, s35, 12
  s_add_u32 s34, s34, s35
  v_add_u32 v16, s34, v4
  v_xor_b32 v17, 32, v16
  v_xor_b32 v18, 64, v16
  v_xor_b32 v19, 96, v16
  v_xor_b32 v20, 4096, v16
  v_xor_b32 v21, 4096, v17
  v_xor_b32 v22, 4096, v18
  v_xor_b32 v23, 4096, v19
  v_bfe_u32 v4, v0, 2, 2
  v_lshl_add_u32 v5, v3, 3, v4
  v_bfe_u32 v6, v0, 4, 1
  v_bfe_u32 v7, v0, 1, 1
  v_lshl_add_u32 v6, v6, 1, v7
  s_lshl_b32 s34, s27, 3
  v_add_u32 v6, s34, v6
  v_lshlrev_b32 v7, 2, v4
  v_xor_b32 v6, v6, v7
  v_lshlrev_b32 v6, 4, v6
  v_and_b32 v7, 1, v0
  v_lshl_add_u32 v6, v7, 3, v6
  v_lshl_add_u32 v6, v5, 8, v6
  v_add_u32 v24, 65536, v6
  v_xor_b32 v25, 64, v24
  v_and_b32 v7, 3, v0
  v_lshlrev_b32 v7, 3, v7
  v_lshl_add_u32 v7, v5, 5, v7
  s_lshl_b32 s34, s27, 11
  s_add_u32 s34, s34, 131072
  v_add_u32 v26, s34, v7
  s_lshl_b32 s34, s24, 2
  s_lshl_b32 s35, s26, 1
  s_add_u32 s34, s34, s35
  s_and_b32 s35, s25, 1
  s_add_u32 s66, s34, s35
  s_lshl_b32 s34, s66, 15
  s_lshl_b32 s35, s25, 13
  s_add_u32 s34, s34, s35
  s_lshl_b32 s35, s27, 12
  s_add_u32 s34, s34, s35
  s_lshl_b32 s35, s23, 21
  s_add_u32 s63, s34, s35
  s_xor_b32 s64, s63, 0x8000
  s_lshl_b32 s66, s66, 10
  s_cmp_eq_u32 s27, 0
  s_cbranch_scc0 K1_QV
  s_waitcnt vmcnt(15)
  s_barrier
  ds_read_b128 v[32:35], v16 offset:0
  ds_read_b64_tr_b16 v[40:41], v24 offset:0
  ds_read_b64_tr_b16 v[42:43], v24 offset:1024
  ds_read_b64_tr_b16 v[44:45], v25 offset:0
  ds_read_b64_tr_b16 v[46:47], v25 offset:1024
  ds_read_b128 v[36:39], v20 offset:0
  ds_read_b64_tr_b16 v[48:49], v26 offset:0
  ds_read_b64_tr_b16 v[50:51], v26 offset:128
  ds_read_b128 v[144:147], v17 offset:0
  ds_read_b64_tr_b16 v[152:153], v24 offset:4096
  ds_read_b64_tr_b16 v[154:155], v24 offset:5120
  ds_read_b64_tr_b16 v[156:157], v25 offset:4096
  ds_read_b64_tr_b16 v[158:159], v25 offset:5120
  ds_read_b128 v[148:151], v21 offset:0
  ds_read_b64_tr_b16 v[160:161], v26 offset:512
  ds_read_b64_tr_b16 v[162:163], v26 offset:640
  s_waitcnt lgkmcnt(8)
  v_mfma_f32_32x32x16_bf16 v[64:79], v[40:43], v[32:35], 0
  v_mfma_f32_32x32x16_bf16 v[80:95], v[44:47], v[32:35], 0
  v_mfma_f32_32x32x16_bf16 v[96:111], v[40:43], v[36:39], 0
  v_mfma_f32_32x32x16_bf16 v[112:127], v[44:47], v[36:39], 0
  v_mfma_f32_32x32x16_bf16 v[128:143], v[48:51], v[32:35], 0
  ds_read_b128 v[32:35], v18 offset:0
  ds_read_b64_tr_b16 v[40:41], v24 offset:8192
  ds_read_b64_tr_b16 v[42:43], v24 offset:9216
  ds_read_b64_tr_b16 v[44:45], v25 offset:8192
  ds_read_b64_tr_b16 v[46:47], v25 offset:9216
  ds_read_b128 v[36:39], v22 offset:0
  ds_read_b64_tr_b16 v[48:49], v26 offset:1024
  ds_read_b64_tr_b16 v[50:51], v26 offset:1152
  s_waitcnt lgkmcnt(8)
  v_mfma_f32_32x32x16_bf16 v[64:79], v[152:155], v[144:147], v[64:79]
  v_mfma_f32_32x32x16_bf16 v[80:95], v[156:159], v[144:147], v[80:95]
  v_mfma_f32_32x32x16_bf16 v[96:111], v[152:155], v[148:151], v[96:111]
  v_mfma_f32_32x32x16_bf16 v[112:127], v[156:159], v[148:151], v[112:127]
  v_mfma_f32_32x32x16_bf16 v[128:143], v[160:163], v[144:147], v[128:143]
  ds_read_b128 v[144:147], v19 offset:0
  ds_read_b64_tr_b16 v[152:153], v24 offset:12288
  ds_read_b64_tr_b16 v[154:155], v24 offset:13312
  ds_read_b64_tr_b16 v[156:157], v25 offset:12288
  ds_read_b64_tr_b16 v[158:159], v25 offset:13312
  ds_read_b128 v[148:151], v23 offset:0
  ds_read_b64_tr_b16 v[160:161], v26 offset:1536
  ds_read_b64_tr_b16 v[162:163], v26 offset:1664
  s_waitcnt lgkmcnt(8)
  v_mfma_f32_32x32x16_bf16 v[64:79], v[40:43], v[32:35], v[64:79]
  v_mfma_f32_32x32x16_bf16 v[80:95], v[44:47], v[32:35], v[80:95]
  v_mfma_f32_32x32x16_bf16 v[96:111], v[40:43], v[36:39], v[96:111]
  v_mfma_f32_32x32x16_bf16 v[112:127], v[44:47], v[36:39], v[112:127]
  v_mfma_f32_32x32x16_bf16 v[128:143], v[48:51], v[32:35], v[128:143]
  s_waitcnt vmcnt(10) lgkmcnt(0)
  s_barrier
  ds_read_b128 v[32:35], v16 offset:16384
  ds_read_b64_tr_b16 v[40:41], v24 offset:16384
  ds_read_b64_tr_b16 v[42:43], v24 offset:17408
  ds_read_b64_tr_b16 v[44:45], v25 offset:16384
  ds_read_b64_tr_b16 v[46:47], v25 offset:17408
  ds_read_b128 v[36:39], v20 offset:16384
  ds_read_b64_tr_b16 v[48:49], v26 offset:4096
  ds_read_b64_tr_b16 v[50:51], v26 offset:4224
  v_mfma_f32_32x32x16_bf16 v[64:79], v[152:155], v[144:147], v[64:79]
  s_add_u32 s98, s3, 4
  s_and_b32 s98, s98, 7
  s_add_u32 m0, s36, 65536
  s_mul_i32 s37, s98, s39
  buffer_load_dwordx4 v10, s[44:47], s37 offen lds
  v_mfma_f32_32x32x16_bf16 v[80:95], v[156:159], v[144:147], v[80:95]
  s_add_u32 m0, s36, 66560
  s_add_u32 s37, s37, s38
  buffer_load_dwordx4 v10, s[44:47], s37 offen lds
  v_mfma_f32_32x32x16_bf16 v[96:111], v[152:155], v[148:151], v[96:111]
  v_mfma_f32_32x32x16_bf16 v[112:127], v[156:159], v[148:151], v[112:127]
  v_mfma_f32_32x32x16_bf16 v[128:143], v[160:163], v[144:147], v[128:143]
  ds_read_b128 v[144:147], v17 offset:16384
  ds_read_b64_tr_b16 v[152:153], v24 offset:20480
  ds_read_b64_tr_b16 v[154:155], v24 offset:21504
  ds_read_b64_tr_b16 v[156:157], v25 offset:20480
  ds_read_b64_tr_b16 v[158:159], v25 offset:21504
  ds_read_b128 v[148:151], v21 offset:16384
  ds_read_b64_tr_b16 v[160:161], v26 offset:4608
  ds_read_b64_tr_b16 v[162:163], v26 offset:4736
  s_waitcnt lgkmcnt(8)
  v_mfma_f32_32x32x16_bf16 v[64:79], v[40:43], v[32:35], v[64:79]
  s_add_u32 m0, s36, 67584
  s_add_u32 s37, s37, s38
  buffer_load_dwordx4 v10, s[44:47], s37 offen lds
  v_mfma_f32_32x32x16_bf16 v[80:95], v[44:47], v[32:35], v[80:95]
  s_add_u32 m0, s36, 68608
  s_add_u32 s37, s37, s38
  buffer_load_dwordx4 v10, s[44:47], s37 offen lds
  v_mfma_f32_32x32x16_bf16 v[96:111], v[40:43], v[36:39], v[96:111]
  v_mfma_f32_32x32x16_bf16 v[112:127], v[44:47], v[36:39], v[112:127]
  v_mfma_f32_32x32x16_bf16 v[128:143], v[48:51], v[32:35], v[128:143]
  ds_read_b128 v[32:35], v18 offset:16384
  ds_read_b64_tr_b16 v[40:41], v24 offset:24576
  ds_read_b64_tr_b16 v[42:43], v24 offset:25600
  ds_read_b64_tr_b16 v[44:45], v25 offset:24576
  ds_read_b64_tr_b16 v[46:47], v25 offset:25600
  ds_read_b128 v[36:39], v22 offset:16384
  ds_read_b64_tr_b16 v[48:49], v26 offset:5120
  ds_read_b64_tr_b16 v[50:51], v26 offset:5248
  s_waitcnt lgkmcnt(8)
  v_mfma_f32_32x32x16_bf16 v[64:79], v[152:155], v[144:147], v[64:79]
  s_add_u32 m0, s60, 131072
  s_lshl_b32 s62, s98, 11
  s_add_u32 s62, s62, s61
  buffer_load_dwordx4 v13, s[48:51], s62 offen lds
  v_mfma_f32_32x32x16_bf16 v[80:95], v[156:159], v[144:147], v[80:95]
  v_mfma_f32_32x32x16_bf16 v[96:111], v[152:155], v[148:151], v[96:111]
  v_mfma_f32_32x32x16_bf16 v[112:127], v[156:159], v[148:151], v[112:127]
  v_mfma_f32_32x32x16_bf16 v[128:143], v[160:163], v[144:147], v[128:143]
  ds_read_b128 v[144:147], v19 offset:16384
  ds_read_b64_tr_b16 v[152:153], v24 offset:28672
  ds_read_b64_tr_b16 v[154:155], v24 offset:29696
  ds_read_b64_tr_b16 v[156:157], v25 offset:28672
  ds_read_b64_tr_b16 v[158:159], v25 offset:29696
  ds_read_b128 v[148:151], v23 offset:16384
  ds_read_b64_tr_b16 v[160:161], v26 offset:5632
  ds_read_b64_tr_b16 v[162:163], v26 offset:5760
  s_waitcnt lgkmcnt(8)
  v_mfma_f32_32x32x16_bf16 v[64:79], v[40:43], v[32:35], v[64:79]
  v_mfma_f32_32x32x16_bf16 v[80:95], v[44:47], v[32:35], v[80:95]
  v_mfma_f32_32x32x16_bf16 v[96:111], v[40:43], v[36:39], v[96:111]
  v_mfma_f32_32x32x16_bf16 v[112:127], v[44:47], v[36:39], v[112:127]
  v_mfma_f32_32x32x16_bf16 v[128:143], v[48:51], v[32:35], v[128:143]
  s_waitcnt vmcnt(10) lgkmcnt(0)
  s_barrier
  ds_read_b128 v[32:35], v16 offset:32768
  ds_read_b64_tr_b16 v[40:41], v24 offset:32768
  ds_read_b64_tr_b16 v[42:43], v24 offset:33792
  ds_read_b64_tr_b16 v[44:45], v25 offset:32768
  ds_read_b64_tr_b16 v[46:47], v25 offset:33792
  ds_read_b128 v[36:39], v20 offset:32768
  ds_read_b64_tr_b16 v[48:49], v26 offset:8192
  ds_read_b64_tr_b16 v[50:51], v26 offset:8320
  v_mfma_f32_32x32x16_bf16 v[64:79], v[152:155], v[144:147], v[64:79]
  s_add_u32 s98, s3, 5
  s_and_b32 s98, s98, 7
  s_add_u32 m0, s36, 81920
  s_mul_i32 s37, s98, s39
  buffer_load_dwordx4 v10, s[44:47], s37 offen lds
  v_mfma_f32_32x32x16_bf16 v[80:95], v[156:159], v[144:147], v[80:95]
  s_add_u32 m0, s36, 82944
  s_add_u32 s37, s37, s38
  buffer_load_dwordx4 v10, s[44:47], s37 offen lds
  v_mfma_f32_32x32x16_bf16 v[96:111], v[152:155], v[148:151], v[96:111]
  v_mfma_f32_32x32x16_bf16 v[112:127], v[156:159], v[148:151], v[112:127]
  v_mfma_f32_32x32x16_bf16 v[128:143], v[160:163], v[144:147], v[128:143]
  ds_read_b128 v[144:147], v17 offset:32768
  ds_read_b64_tr_b16 v[152:153], v24 offset:36864
  ds_read_b64_tr_b16 v[154:155], v24 offset:37888
  ds_read_b64_tr_b16 v[156:157], v25 offset:36864
  ds_read_b64_tr_b16 v[158:159], v25 offset:37888
  ds_read_b128 v[148:151], v21 offset:32768
  ds_read_b64_tr_b16 v[160:161], v26 offset:8704
  ds_read_b64_tr_b16 v[162:163], v26 offset:8832
  s_waitcnt lgkmcnt(8)
  v_mfma_f32_32x32x16_bf16 v[64:79], v[40:43], v[32:35], v[64:79]
  s_add_u32 m0, s36, 83968
  s_add_u32 s37, s37, s38
  buffer_load_dwordx4 v10, s[44:47], s37 offen lds
  v_mfma_f32_32x32x16_bf16 v[80:95], v[44:47], v[32:35], v[80:95]
  s_add_u32 m0, s36, 84992
  s_add_u32 s37, s37, s38
  buffer_load_dwordx4 v10, s[44:47], s37 offen lds
  v_mfma_f32_32x32x16_bf16 v[96:111], v[40:43], v[36:39], v[96:111]
  v_mfma_f32_32x32x16_bf16 v[112:127], v[44:47], v[36:39], v[112:127]
  v_mfma_f32_32x32x16_bf16 v[128:143], v[48:51], v[32:35], v[128:143]
  ds_read_b128 v[32:35], v18 offset:32768
  ds_read_b64_tr_b16 v[40:41], v24 offset:40960
  ds_read_b64_tr_b16 v[42:43], v24 offset:41984
  ds_read_b64_tr_b16 v[44:45], v25 offset:40960
  ds_read_b64_tr_b16 v[46:47], v25 offset:41984
  ds_read_b128 v[36:39], v22 offset:32768
  ds_read_b64_tr_b16 v[48:49], v26 offset:9216
  ds_read_b64_tr_b16 v[50:51], v26 offset:9344
  s_waitcnt lgkmcnt(8)
  v_mfma_f32_32x32x16_bf16 v[64:79], v[152:155], v[144:147], v[64:79]
  s_add_u32 m0, s60, 135168
  s_lshl_b32 s62, s98, 11
  s_add_u32 s62, s62, s61
  buffer_load_dwordx4 v13, s[48:51], s62 offen lds
  v_mfma_f32_32x32x16_bf16 v[80:95], v[156:159], v[144:147], v[80:95]
  v_mfma_f32_32x32x16_bf16 v[96:111], v[152:155], v[148:151], v[96:111]
  v_mfma_f32_32x32x16_bf16 v[112:127], v[156:159], v[148:151], v[112:127]
  v_mfma_f32_32x32x16_bf16 v[128:143], v[160:163], v[144:147], v[128:143]
  ds_read_b128 v[144:147], v19 offset:32768
  ds_read_b64_tr_b16 v[152:153], v24 offset:45056
  ds_read_b64_tr_b16 v[154:155], v24 offset:46080
  ds_read_b64_tr_b16 v[156:157], v25 offset:45056
  ds_read_b64_tr_b16 v[158:159], v25 offset:46080
  ds_read_b128 v[148:151], v23 offset:32768
  ds_read_b64_tr_b16 v[160:161], v26 offset:9728
  ds_read_b64_tr_b16 v[162:163], v26 offset:9856
  s_waitcnt lgkmcnt(8)
  v_mfma_f32_32x32x16_bf16 v[64:79], v[40:43], v[32:35], v[64:79]
  v_mfma_f32_32x32x16_bf16 v[80:95], v[44:47], v[32:35], v[80:95]
  v_mfma_f32_32x32x16_bf16 v[96:111], v[40:43], v[36:39], v[96:111]
  v_mfma_f32_32x32x16_bf16 v[112:127], v[44:47], v[36:39], v[112:127]
  v_mfma_f32_32x32x16_bf16 v[128:143], v[48:51], v[32:35], v[128:143]
  s_waitcnt vmcnt(10) lgkmcnt(0)
  s_barrier
  ds_read_b128 v[32:35], v16 offset:49152
  ds_read_b64_tr_b16 v[40:41], v24 offset:49152
  ds_read_b64_tr_b16 v[42:43], v24 offset:50176
  ds_read_b64_tr_b16 v[44:45], v25 offset:49152
  ds_read_b64_tr_b16 v[46:47], v25 offset:50176
  ds_read_b128 v[36:39], v20 offset:49152
  ds_read_b64_tr_b16 v[48:49], v26 offset:12288
  ds_read_b64_tr_b16 v[50:51], v26 offset:12416
  v_mfma_f32_32x32x16_bf16 v[64:79], v[152:155], v[144:147], v[64:79]
  s_add_u32 s98, s3, 6
  s_and_b32 s98, s98, 7
  s_add_u32 m0, s36, 98304
  s_mul_i32 s37, s98, s39
  buffer_load_dwordx4 v10, s[44:47], s37 offen lds
  v_mfma_f32_32x32x16_bf16 v[80:95], v[156:159], v[144:147], v[80:95]
  s_add_u32 m0, s36, 99328
  s_add_u32 s37, s37, s38
  buffer_load_dwordx4 v10, s[44:47], s37 offen lds
  v_mfma_f32_32x32x16_bf16 v[96:111], v[152:155], v[148:151], v[96:111]
  v_mfma_f32_32x32x16_bf16 v[112:127], v[156:159], v[148:151], v[112:127]
  v_mfma_f32_32x32x16_bf16 v[128:143], v[160:163], v[144:147], v[128:143]
  ds_read_b128 v[144:147], v17 offset:49152
  ds_read_b64_tr_b16 v[152:153], v24 offset:53248
  ds_read_b64_tr_b16 v[154:155], v24 offset:54272
  ds_read_b64_tr_b16 v[156:157], v25 offset:53248
  ds_read_b64_tr_b16 v[158:159], v25 offset:54272
  ds_read_b128 v[148:151], v21 offset:49152
  ds_read_b64_tr_b16 v[160:161], v26 offset:12800
  ds_read_b64_tr_b16 v[162:163], v26 offset:12928
  s_waitcnt lgkmcnt(8)
  v_mfma_f32_32x32x16_bf16 v[64:79], v[40:43], v[32:35], v[64:79]
  s_add_u32 m0, s36, 100352
  s_add_u32 s37, s37, s38
  buffer_load_dwordx4 v10, s[44:47], s37 offen lds
  v_mfma_f32_32x32x16_bf16 v[80:95], v[44:47], v[32:35], v[80:95]
  s_add_u32 m0, s36, 101376
  s_add_u32 s37, s37, s38
  buffer_load_dwordx4 v10, s[44:47], s37 offen lds
  v_mfma_f32_32x32x16_bf16 v[96:111], v[40:43], v[36:39], v[96:111]
  v_mfma_f32_32x32x16_bf16 v[112:127], v[44:47], v[36:39], v[112:127]
  v_mfma_f32_32x32x16_bf16 v[128:143], v[48:51], v[32:35], v[128:143]
  ds_read_b128 v[32:35], v18 offset:49152
  ds_read_b64_tr_b16 v[40:41], v24 offset:57344
  ds_read_b64_tr_b16 v[42:43], v24 offset:58368
  ds_read_b64_tr_b16 v[44:45], v25 offset:57344
  ds_read_b64_tr_b16 v[46:47], v25 offset:58368
  ds_read_b128 v[36:39], v22 offset:49152
  ds_read_b64_tr_b16 v[48:49], v26 offset:13312
  ds_read_b64_tr_b16 v[50:51], v26 offset:13440
  s_waitcnt lgkmcnt(8)
  v_mfma_f32_32x32x16_bf16 v[64:79], v[152:155], v[144:147], v[64:79]
  s_add_u32 m0, s60, 139264
  s_lshl_b32 s62, s98, 11
  s_add_u32 s62, s62, s61
  buffer_load_dwordx4 v13, s[48:51], s62 offen lds
  v_mfma_f32_32x32x16_bf16 v[80:95], v[156:159], v[144:147], v[80:95]
  v_mfma_f32_32x32x16_bf16 v[96:111], v[152:155], v[148:151], v[96:111]
  v_mfma_f32_32x32x16_bf16 v[112:127], v[156:159], v[148:151], v[112:127]
  v_mfma_f32_32x32x16_bf16 v[128:143], v[160:163], v[144:147], v[128:143]
  ds_read_b128 v[144:147], v19 offset:49152
  ds_read_b64_tr_b16 v[152:153], v24 offset:61440
  ds_read_b64_tr_b16 v[154:155], v24 offset:62464
  ds_read_b64_tr_b16 v[156:157], v25 offset:61440
  ds_read_b64_tr_b16 v[158:159], v25 offset:62464
  ds_read_b128 v[148:151], v23 offset:49152
  ds_read_b64_tr_b16 v[160:161], v26 offset:13824
  ds_read_b64_tr_b16 v[162:163], v26 offset:13952
  s_waitcnt lgkmcnt(8)
  v_mfma_f32_32x32x16_bf16 v[64:79], v[40:43], v[32:35], v[64:79]
  v_mfma_f32_32x32x16_bf16 v[80:95], v[44:47], v[32:35], v[80:95]
  v_mfma_f32_32x32x16_bf16 v[96:111], v[40:43], v[36:39], v[96:111]
  v_mfma_f32_32x32x16_bf16 v[112:127], v[44:47], v[36:39], v[112:127]
  v_mfma_f32_32x32x16_bf16 v[128:143], v[48:51], v[32:35], v[128:143]
  s_waitcnt vmcnt(10) lgkmcnt(0)
  s_barrier
  ds_read_b128 v[32:35], v16 offset:0
  ds_read_b64_tr_b16 v[40:41], v24 offset:0
  ds_read_b64_tr_b16 v[42:43], v24 offset:1024
  ds_read_b64_tr_b16 v[44:45], v25 offset:0
  ds_read_b64_tr_b16 v[46:47], v25 offset:1024
  ds_read_b128 v[36:39], v20 offset:0
  ds_read_b64_tr_b16 v[48:49], v26 offset:0
  ds_read_b64_tr_b16 v[50:51], v26 offset:128
  v_mfma_f32_32x32x16_bf16 v[64:79], v[152:155], v[144:147], v[64:79]
  s_add_u32 s98, s3, 7
  s_and_b32 s98, s98, 7
  s_add_u32 m0, s36, 114688
  s_mul_i32 s37, s98, s39
  buffer_load_dwordx4 v10, s[44:47], s37 offen lds
  v_mfma_f32_32x32x16_bf16 v[80:95], v[156:159], v[144:147], v[80:95]
  s_add_u32 m0, s36, 115712
  s_add_u32 s37, s37, s38
  buffer_load_dwordx4 v10, s[44:47], s37 offen lds
  v_mfma_f32_32x32x16_bf16 v[96:111], v[152:155], v[148:151], v[96:111]
  v_mfma_f32_32x32x16_bf16 v[112:127], v[156:159], v[148:151], v[112:127]
  v_mfma_f32_32x32x16_bf16 v[128:143], v[160:163], v[144:147], v[128:143]
  ds_read_b128 v[144:147], v17 offset:0
  ds_read_b64_tr_b16 v[152:153], v24 offset:4096
  ds_read_b64_tr_b16 v[154:155], v24 offset:5120
  ds_read_b64_tr_b16 v[156:157], v25 offset:4096
  ds_read_b64_tr_b16 v[158:159], v25 offset:5120
  ds_read_b128 v[148:151], v21 offset:0
  ds_read_b64_tr_b16 v[160:161], v26 offset:512
  ds_read_b64_tr_b16 v[162:163], v26 offset:640
  s_waitcnt lgkmcnt(8)
  v_mfma_f32_32x32x16_bf16 v[64:79], v[40:43], v[32:35], v[64:79]
  s_add_u32 m0, s36, 116736
  s_add_u32 s37, s37, s38
  buffer_load_dwordx4 v10, s[44:47], s37 offen lds
  v_mfma_f32_32x32x16_bf16 v[80:95], v[44:47], v[32:35], v[80:95]
  s_add_u32 m0, s36, 117760
  s_add_u32 s37, s37, s38
  buffer_load_dwordx4 v10, s[44:47], s37 offen lds
  v_mfma_f32_32x32x16_bf16 v[96:111], v[40:43], v[36:39], v[96:111]
  v_mfma_f32_32x32x16_bf16 v[112:127], v[44:47], v[36:39], v[112:127]
  v_mfma_f32_32x32x16_bf16 v[128:143], v[48:51], v[32:35], v[128:143]
  ds_read_b128 v[32:35], v18 offset:0
  ds_read_b64_tr_b16 v[40:41], v24 offset:8192
  ds_read_b64_tr_b16 v[42:43], v24 offset:9216
  ds_read_b64_tr_b16 v[44:45], v25 offset:8192
  ds_read_b64_tr_b16 v[46:47], v25 offset:9216
  ds_read_b128 v[36:39], v22 offset:0
  ds_read_b64_tr_b16 v[48:49], v26 offset:1024
  ds_read_b64_tr_b16 v[50:51], v26 offset:1152
  s_waitcnt lgkmcnt(8)
  v_mfma_f32_32x32x16_bf16 v[64:79], v[152:155], v[144:147], v[64:79]
  s_add_u32 m0, s60, 143360
  s_lshl_b32 s62, s98, 11
  s_add_u32 s62, s62, s61
  buffer_load_dwordx4 v13, s[48:51], s62 offen lds
  v_mfma_f32_32x32x16_bf16 v[80:95], v[156:159], v[144:147], v[80:95]
  v_mfma_f32_32x32x16_bf16 v[96:111], v[152:155], v[148:151], v[96:111]
  v_mfma_f32_32x32x16_bf16 v[112:127], v[156:159], v[148:151], v[112:127]
  v_mfma_f32_32x32x16_bf16 v[128:143], v[160:163], v[144:147], v[128:143]
  ds_read_b128 v[144:147], v19 offset:0
  ds_read_b64_tr_b16 v[152:153], v24 offset:12288
  ds_read_b64_tr_b16 v[154:155], v24 offset:13312
  ds_read_b64_tr_b16 v[156:157], v25 offset:12288
  ds_read_b64_tr_b16 v[158:159], v25 offset:13312
  ds_read_b128 v[148:151], v23 offset:0
  ds_read_b64_tr_b16 v[160:161], v26 offset:1536
  ds_read_b64_tr_b16 v[162:163], v26 offset:1664
  s_waitcnt lgkmcnt(8)
  v_mfma_f32_32x32x16_bf16 v[64:79], v[40:43], v[32:35], v[64:79]
  v_mfma_f32_32x32x16_bf16 v[80:95], v[44:47], v[32:35], v[80:95]
  v_mfma_f32_32x32x16_bf16 v[96:111], v[40:43], v[36:39], v[96:111]
  v_mfma_f32_32x32x16_bf16 v[112:127], v[44:47], v[36:39], v[112:127]
  v_mfma_f32_32x32x16_bf16 v[128:143], v[48:51], v[32:35], v[128:143]
  s_waitcnt vmcnt(10) lgkmcnt(0)
  s_barrier
  ds_read_b128 v[32:35], v16 offset:16384
  ds_read_b64_tr_b16 v[40:41], v24 offset:16384
  ds_read_b64_tr_b16 v[42:43], v24 offset:17408
  ds_read_b64_tr_b16 v[44:45], v25 offset:16384
  ds_read_b64_tr_b16 v[46:47], v25 offset:17408
  ds_read_b128 v[36:39], v20 offset:16384
  ds_read_b64_tr_b16 v[48:49], v26 offset:4096
  ds_read_b64_tr_b16 v[50:51], v26 offset:4224
  v_mfma_f32_32x32x16_bf16 v[64:79], v[152:155], v[144:147], v[64:79]
  v_mfma_f32_32x32x16_bf16 v[80:95], v[156:159], v[144:147], v[80:95]
  v_mfma_f32_32x32x16_bf16 v[96:111], v[152:155], v[148:151], v[96:111]
  v_mfma_f32_32x32x16_bf16 v[112:127], v[156:159], v[148:151], v[112:127]
  v_mfma_f32_32x32x16_bf16 v[128:143], v[160:163], v[144:147], v[128:143]
  ds_read_b128 v[144:147], v17 offset:16384
  ds_read_b64_tr_b16 v[152:153], v24 offset:20480
  ds_read_b64_tr_b16 v[154:155], v24 offset:21504
  ds_read_b64_tr_b16 v[156:157], v25 offset:20480
  ds_read_b64_tr_b16 v[158:159], v25 offset:21504
  ds_read_b128 v[148:151], v21 offset:16384
  ds_read_b64_tr_b16 v[160:161], v26 offset:4608
  ds_read_b64_tr_b16 v[162:163], v26 offset:4736
  s_waitcnt lgkmcnt(8)
  v_mfma_f32_32x32x16_bf16 v[64:79], v[40:43], v[32:35], v[64:79]
  v_mfma_f32_32x32x16_bf16 v[80:95], v[44:47], v[32:35], v[80:95]
  v_mfma_f32_32x32x16_bf16 v[96:111], v[40:43], v[36:39], v[96:111]
  v_mfma_f32_32x32x16_bf16 v[112:127], v[44:47], v[36:39], v[112:127]
  v_mfma_f32_32x32x16_bf16 v[128:143], v[48:51], v[32:35], v[128:143]
  ds_read_b128 v[32:35], v18 offset:16384
  ds_read_b64_tr_b16 v[40:41], v24 offset:24576
  ds_read_b64_tr_b16 v[42:43], v24 offset:25600
  ds_read_b64_tr_b16 v[44:45], v25 offset:24576
  ds_read_b64_tr_b16 v[46:47], v25 offset:25600
  ds_read_b128 v[36:39], v22 offset:16384
  ds_read_b64_tr_b16 v[48:49], v26 offset:5120
  ds_read_b64_tr_b16 v[50:51], v26 offset:5248
  s_waitcnt lgkmcnt(8)
  v_mfma_f32_32x32x16_bf16 v[64:79], v[152:155], v[144:147], v[64:79]
  v_mfma_f32_32x32x16_bf16 v[80:95], v[156:159], v[144:147], v[80:95]
  v_mfma_f32_32x32x16_bf16 v[96:111], v[152:155], v[148:151], v[96:111]
  v_mfma_f32_32x32x16_bf16 v[112:127], v[156:159], v[148:151], v[112:127]
  v_mfma_f32_32x32x16_bf16 v[128:143], v[160:163], v[144:147], v[128:143]
  ds_read_b128 v[144:147], v19 offset:16384
  ds_read_b64_tr_b16 v[152:153], v24 offset:28672
  ds_read_b64_tr_b16 v[154:155], v24 offset:29696
  ds_read_b64_tr_b16 v[156:157], v25 offset:28672
  ds_read_b64_tr_b16 v[158:159], v25 offset:29696
  ds_read_b128 v[148:151], v23 offset:16384
  ds_read_b64_tr_b16 v[160:161], v26 offset:5632
  ds_read_b64_tr_b16 v[162:163], v26 offset:5760
  s_waitcnt lgkmcnt(8)
  v_mfma_f32_32x32x16_bf16 v[64:79], v[40:43], v[32:35], v[64:79]
  v_mfma_f32_32x32x16_bf16 v[80:95], v[44:47], v[32:35], v[80:95]
  v_mfma_f32_32x32x16_bf16 v[96:111], v[40:43], v[36:39], v[96:111]
  v_mfma_f32_32x32x16_bf16 v[112:127], v[44:47], v[36:39], v[112:127]
  v_mfma_f32_32x32x16_bf16 v[128:143], v[48:51], v[32:35], v[128:143]
  s_waitcnt vmcnt(5) lgkmcnt(0)
  s_barrier
  ds_read_b128 v[32:35], v16 offset:32768
  ds_read_b64_tr_b16 v[40:41], v24 offset:32768
  ds_read_b64_tr_b16 v[42:43], v24 offset:33792
  ds_read_b64_tr_b16 v[44:45], v25 offset:32768
  ds_read_b64_tr_b16 v[46:47], v25 offset:33792
  ds_read_b128 v[36:39], v20 offset:32768
  ds_read_b64_tr_b16 v[48:49], v26 offset:8192
  ds_read_b64_tr_b16 v[50:51], v26 offset:8320
  v_mfma_f32_32x32x16_bf16 v[64:79], v[152:155], v[144:147], v[64:79]
  v_mfma_f32_32x32x16_bf16 v[80:95], v[156:159], v[144:147], v[80:95]
  v_mfma_f32_32x32x16_bf16 v[96:111], v[152:155], v[148:151], v[96:111]
  v_mfma_f32_32x32x16_bf16 v[112:127], v[156:159], v[148:151], v[112:127]
  v_mfma_f32_32x32x16_bf16 v[128:143], v[160:163], v[144:147], v[128:143]
  ds_read_b128 v[144:147], v17 offset:32768
  ds_read_b64_tr_b16 v[152:153], v24 offset:36864
  ds_read_b64_tr_b16 v[154:155], v24 offset:37888
  ds_read_b64_tr_b16 v[156:157], v25 offset:36864
  ds_read_b64_tr_b16 v[158:159], v25 offset:37888
  ds_read_b128 v[148:151], v21 offset:32768
  ds_read_b64_tr_b16 v[160:161], v26 offset:8704
  ds_read_b64_tr_b16 v[162:163], v26 offset:8832
  s_waitcnt lgkmcnt(8)
  v_mfma_f32_32x32x16_bf16 v[64:79], v[40:43], v[32:35], v[64:79]
  v_mfma_f32_32x32x16_bf16 v[80:95], v[44:47], v[32:35], v[80:95]
  v_mfma_f32_32x32x16_bf16 v[96:111], v[40:43], v[36:39], v[96:111]
  v_mfma_f32_32x32x16_bf16 v[112:127], v[44:47], v[36:39], v[112:127]
  v_mfma_f32_32x32x16_bf16 v[128:143], v[48:51], v[32:35], v[128:143]
  ds_read_b128 v[32:35], v18 offset:32768
  ds_read_b64_tr_b16 v[40:41], v24 offset:40960
  ds_read_b64_tr_b16 v[42:43], v24 offset:41984
  ds_read_b64_tr_b16 v[44:45], v25 offset:40960
  ds_read_b64_tr_b16 v[46:47], v25 offset:41984
  ds_read_b128 v[36:39], v22 offset:32768
  ds_read_b64_tr_b16 v[48:49], v26 offset:9216
  ds_read_b64_tr_b16 v[50:51], v26 offset:9344
  s_waitcnt lgkmcnt(8)
  v_mfma_f32_32x32x16_bf16 v[64:79], v[152:155], v[144:147], v[64:79]
  v_mfma_f32_32x32x16_bf16 v[80:95], v[156:159], v[144:147], v[80:95]
  v_mfma_f32_32x32x16_bf16 v[96:111], v[152:155], v[148:151], v[96:111]
  v_mfma_f32_32x32x16_bf16 v[112:127], v[156:159], v[148:151], v[112:127]
  v_mfma_f32_32x32x16_bf16 v[128:143], v[160:163], v[144:147], v[128:143]
  ds_read_b128 v[144:147], v19 offset:32768
  ds_read_b64_tr_b16 v[152:153], v24 offset:45056
  ds_read_b64_tr_b16 v[154:155], v24 offset:46080
  ds_read_b64_tr_b16 v[156:157], v25 offset:45056
  ds_read_b64_tr_b16 v[158:159], v25 offset:46080
  ds_read_b128 v[148:151], v23 offset:32768
  ds_read_b64_tr_b16 v[160:161], v26 offset:9728
  ds_read_b64_tr_b16 v[162:163], v26 offset:9856
  s_waitcnt lgkmcnt(8)
  v_mfma_f32_32x32x16_bf16 v[64:79], v[40:43], v[32:35], v[64:79]
  v_mfma_f32_32x32x16_bf16 v[80:95], v[44:47], v[32:35], v[80:95]
  v_mfma_f32_32x32x16_bf16 v[96:111], v[40:43], v[36:39], v[96:111]
  v_mfma_f32_32x32x16_bf16 v[112:127], v[44:47], v[36:39], v[112:127]
  v_mfma_f32_32x32x16_bf16 v[128:143], v[48:51], v[32:35], v[128:143]
  s_waitcnt vmcnt(0) lgkmcnt(0)
  s_barrier
  ds_read_b128 v[32:35], v16 offset:49152
  ds_read_b64_tr_b16 v[40:41], v24 offset:49152
  ds_read_b64_tr_b16 v[42:43], v24 offset:50176
  ds_read_b64_tr_b16 v[44:45], v25 offset:49152
  ds_read_b64_tr_b16 v[46:47], v25 offset:50176
  ds_read_b128 v[36:39], v20 offset:49152
  ds_read_b64_tr_b16 v[48:49], v26 offset:12288
  ds_read_b64_tr_b16 v[50:51], v26 offset:12416
  v_mfma_f32_32x32x16_bf16 v[64:79], v[152:155], v[144:147], v[64:79]
  v_mfma_f32_32x32x16_bf16 v[80:95], v[156:159], v[144:147], v[80:95]
  v_mfma_f32_32x32x16_bf16 v[96:111], v[152:155], v[148:151], v[96:111]
  v_mfma_f32_32x32x16_bf16 v[112:127], v[156:159], v[148:151], v[112:127]
  v_mfma_f32_32x32x16_bf16 v[128:143], v[160:163], v[144:147], v[128:143]
  ds_read_b128 v[144:147], v17 offset:49152
  ds_read_b64_tr_b16 v[152:153], v24 offset:53248
  ds_read_b64_tr_b16 v[154:155], v24 offset:54272
  ds_read_b64_tr_b16 v[156:157], v25 offset:53248
  ds_read_b64_tr_b16 v[158:159], v25 offset:54272
  ds_read_b128 v[148:151], v21 offset:49152
  ds_read_b64_tr_b16 v[160:161], v26 offset:12800
  ds_read_b64_tr_b16 v[162:163], v26 offset:12928
  s_waitcnt lgkmcnt(8)
  v_mfma_f32_32x32x16_bf16 v[64:79], v[40:43], v[32:35], v[64:79]
  v_mfma_f32_32x32x16_bf16 v[80:95], v[44:47], v[32:35], v[80:95]
  v_mfma_f32_32x32x16_bf16 v[96:111], v[40:43], v[36:39], v[96:111]
  v_mfma_f32_32x32x16_bf16 v[112:127], v[44:47], v[36:39], v[112:127]
  v_mfma_f32_32x32x16_bf16 v[128:143], v[48:51], v[32:35], v[128:143]
  ds_read_b128 v[32:35], v18 offset:49152
  ds_read_b64_tr_b16 v[40:41], v24 offset:57344
  ds_read_b64_tr_b16 v[42:43], v24 offset:58368
  ds_read_b64_tr_b16 v[44:45], v25 offset:57344
  ds_read_b64_tr_b16 v[46:47], v25 offset:58368
  ds_read_b128 v[36:39], v22 offset:49152
  ds_read_b64_tr_b16 v[48:49], v26 offset:13312
  ds_read_b64_tr_b16 v[50:51], v26 offset:13440
  s_waitcnt lgkmcnt(8)
  v_mfma_f32_32x32x16_bf16 v[64:79], v[152:155], v[144:147], v[64:79]
  v_mfma_f32_32x32x16_bf16 v[80:95], v[156:159], v[144:147], v[80:95]
  v_mfma_f32_32x32x16_bf16 v[96:111], v[152:155], v[148:151], v[96:111]
  v_mfma_f32_32x32x16_bf16 v[112:127], v[156:159], v[148:151], v[112:127]
  v_mfma_f32_32x32x16_bf16 v[128:143], v[160:163], v[144:147], v[128:143]
  ds_read_b128 v[144:147], v19 offset:49152
  ds_read_b64_tr_b16 v[152:153], v24 offset:61440
  ds_read_b64_tr_b16 v[154:155], v24 offset:62464
  ds_read_b64_tr_b16 v[156:157], v25 offset:61440
  ds_read_b64_tr_b16 v[158:159], v25 offset:62464
  ds_read_b128 v[148:151], v23 offset:49152
  ds_read_b64_tr_b16 v[160:161], v26 offset:13824
  ds_read_b64_tr_b16 v[162:163], v26 offset:13952
  s_waitcnt lgkmcnt(8)
  v_mfma_f32_32x32x16_bf16 v[64:79], v[40:43], v[32:35], v[64:79]
  v_mfma_f32_32x32x16_bf16 v[80:95], v[44:47], v[32:35], v[80:95]
  v_mfma_f32_32x32x16_bf16 v[96:111], v[40:43], v[36:39], v[96:111]
  v_mfma_f32_32x32x16_bf16 v[112:127], v[44:47], v[36:39], v[112:127]
  v_mfma_f32_32x32x16_bf16 v[128:143], v[48:51], v[32:35], v[128:143]
  s_waitcnt vmcnt(0) lgkmcnt(0)
  s_barrier
  v_mfma_f32_32x32x16_bf16 v[64:79], v[152:155], v[144:147], v[64:79]
  v_mfma_f32_32x32x16_bf16 v[80:95], v[156:159], v[144:147], v[80:95]
  v_mfma_f32_32x32x16_bf16 v[96:111], v[152:155], v[148:151], v[96:111]
  v_mfma_f32_32x32x16_bf16 v[112:127], v[156:159], v[148:151], v[112:127]
  v_mfma_f32_32x32x16_bf16 v[128:143], v[160:163], v[144:147], v[128:143]
  s_nop 7
  s_nop 3
  v_cvt_pk_bf16_f32 v64, v64, v65
  v_cvt_pk_bf16_f32 v65, v66, v67
  v_cvt_pk_bf16_f32 v66, v68, v69
  v_cvt_pk_bf16_f32 v67, v70, v71
  v_cvt_pk_bf16_f32 v68, v72, v73
  v_cvt_pk_bf16_f32 v69, v74, v75
  v_cvt_pk_bf16_f32 v70, v76, v77
  v_cvt_pk_bf16_f32 v71, v78, v79
  buffer_store_dwordx4 v[64:67], v13, s[56:59], s63 offen offset:0 sc1
  buffer_store_dwordx4 v[68:71], v13, s[56:59], s63 offen offset:1024 sc1
  v_cvt_pk_bf16_f32 v80, v80, v81
  v_cvt_pk_bf16_f32 v81, v82, v83
  v_cvt_pk_bf16_f32 v82, v84, v85
  v_cvt_pk_bf16_f32 v83, v86, v87
  v_cvt_pk_bf16_f32 v84, v88, v89
  v_cvt_pk_bf16_f32 v85, v90, v91
  v_cvt_pk_bf16_f32 v86, v92, v93
  v_cvt_pk_bf16_f32 v87, v94, v95
  buffer_store_dwordx4 v[80:83], v13, s[56:59], s63 offen offset:2048 sc1
  buffer_store_dwordx4 v[84:87], v13, s[56:59], s63 offen offset:3072 sc1
  v_cvt_pk_bf16_f32 v96, v96, v97
  v_cvt_pk_bf16_f32 v97, v98, v99
  v_cvt_pk_bf16_f32 v98, v100, v101
  v_cvt_pk_bf16_f32 v99, v102, v103
  v_cvt_pk_bf16_f32 v100, v104, v105
  v_cvt_pk_bf16_f32 v101, v106, v107
  v_cvt_pk_bf16_f32 v102, v108, v109
  v_cvt_pk_bf16_f32 v103, v110, v111
  buffer_store_dwordx4 v[96:99], v13, s[56:59], s64 offen offset:0 sc1
  buffer_store_dwordx4 v[100:103], v13, s[56:59], s64 offen offset:1024 sc1
  v_cvt_pk_bf16_f32 v112, v112, v113
  v_cvt_pk_bf16_f32 v113, v114, v115
  v_cvt_pk_bf16_f32 v114, v116, v117
  v_cvt_pk_bf16_f32 v115, v118, v119
  v_cvt_pk_bf16_f32 v116, v120, v121
  v_cvt_pk_bf16_f32 v117, v122, v123
  v_cvt_pk_bf16_f32 v118, v124, v125
  v_cvt_pk_bf16_f32 v119, v126, v127
  buffer_store_dwordx4 v[112:115], v13, s[56:59], s64 offen offset:2048 sc1
  buffer_store_dwordx4 v[116:119], v13, s[56:59], s64 offen offset:3072 sc1
  s_lshl_b32 s34, s23, 2
  s_add_u32 s34, s34, s25
  s_cmp_lt_u32 s34, 2
  s_cbranch_scc0 K1_SIG
  v_mul_f32 v128, 0x3eb8aa3b, v128
  v_mul_f32 v129, 0x3eb8aa3b, v129
  v_mul_f32 v130, 0x3eb8aa3b, v130
  v_mul_f32 v131, 0x3eb8aa3b, v131
  v_mul_f32 v132, 0x3eb8aa3b, v132
  v_mul_f32 v133, 0x3eb8aa3b, v133
  v_mul_f32 v134, 0x3eb8aa3b, v134
  v_mul_f32 v135, 0x3eb8aa3b, v135
  v_cvt_pk_bf16_f32 v128, v128, v129
  v_cvt_pk_bf16_f32 v129, v130, v131
  v_cvt_pk_bf16_f32 v130, v132, v133
  v_cvt_pk_bf16_f32 v131, v134, v135
  v_and_b32 v2, 0x33, v0
  v_bfe_u32 v3, v0, 2, 1
  v_bfe_u32 v4, v0, 3, 1
  v_lshl_or_b32 v2, v3, 3, v2
  v_lshl_or_b32 v2, v4, 2, v2
  v_lshlrev_b32 v2, 4, v2
  s_add_u32 s66, s66, 4194304
  buffer_store_dwordx4 v[128:131], v2, s[56:59], s66 offen sc1
  s_branch K1_SIG
K1_QV:
  s_waitcnt vmcnt(15)
  s_barrier
  ds_read_b128 v[32:35], v16 offset:0
  ds_read_b64_tr_b16 v[40:41], v24 offset:0
  ds_read_b64_tr_b16 v[42:43], v24 offset:1024
  ds_read_b64_tr_b16 v[44:45], v25 offset:0
  ds_read_b64_tr_b16 v[46:47], v25 offset:1024
  ds_read_b128 v[36:39], v20 offset:0
  ds_read_b64_tr_b16 v[48:49], v26 offset:0
  ds_read_b64_tr_b16 v[50:51], v26 offset:128
  ds_read_b128 v[144:147], v17 offset:0
  ds_read_b64_tr_b16 v[152:153], v24 offset:4096
  ds_read_b64_tr_b16 v[154:155], v24 offset:5120
  ds_read_b64_tr_b16 v[156:157], v25 offset:4096
  ds_read_b64_tr_b16 v[158:159], v25 offset:5120
  ds_read_b128 v[148:151], v21 offset:0
  ds_read_b64_tr_b16 v[160:161], v26 offset:512
  ds_read_b64_tr_b16 v[162:163], v26 offset:640
  s_waitcnt lgkmcnt(8)
  v_mfma_f32_32x32x16_bf16 v[64:79], v[40:43], v[32:35], 0
  v_mfma_f32_32x32x16_bf16 v[80:95], v[44:47], v[32:35], 0
  v_mfma_f32_32x32x16_bf16 v[96:111], v[40:43], v[36:39], 0
  v_mfma_f32_32x32x16_bf16 v[112:127], v[44:47], v[36:39], 0
  v_mfma_f32_32x32x16_bf16 v[128:143], v[32:35], v[48:51], 0
  ds_read_b128 v[32:35], v18 offset:0
  ds_read_b64_tr_b16 v[40:41], v24 offset:8192
  ds_read_b64_tr_b16 v[42:43], v24 offset:9216
  ds_read_b64_tr_b16 v[44:45], v25 offset:8192
  ds_read_b64_tr_b16 v[46:47], v25 offset:9216
  ds_read_b128 v[36:39], v22 offset:0
  ds_read_b64_tr_b16 v[48:49], v26 offset:1024
  ds_read_b64_tr_b16 v[50:51], v26 offset:1152
  s_waitcnt lgkmcnt(8)
  v_mfma_f32_32x32x16_bf16 v[64:79], v[152:155], v[144:147], v[64:79]
  v_mfma_f32_32x32x16_bf16 v[80:95], v[156:159], v[144:147], v[80:95]
  v_mfma_f32_32x32x16_bf16 v[96:111], v[152:155], v[148:151], v[96:111]
  v_mfma_f32_32x32x16_bf16 v[112:127], v[156:159], v[148:151], v[112:127]
  v_mfma_f32_32x32x16_bf16 v[128:143], v[144:147], v[160:163], v[128:143]
  ds_read_b128 v[144:147], v19 offset:0
  ds_read_b64_tr_b16 v[152:153], v24 offset:12288
  ds_read_b64_tr_b16 v[154:155], v24 offset:13312
  ds_read_b64_tr_b16 v[156:157], v25 offset:12288
  ds_read_b64_tr_b16 v[158:159], v25 offset:13312
  ds_read_b128 v[148:151], v23 offset:0
  ds_read_b64_tr_b16 v[160:161], v26 offset:1536
  ds_read_b64_tr_b16 v[162:163], v26 offset:1664
  s_waitcnt lgkmcnt(8)
  v_mfma_f32_32x32x16_bf16 v[64:79], v[40:43], v[32:35], v[64:79]
  v_mfma_f32_32x32x16_bf16 v[80:95], v[44:47], v[32:35], v[80:95]
  v_mfma_f32_32x32x16_bf16 v[96:111], v[40:43], v[36:39], v[96:111]
  v_mfma_f32_32x32x16_bf16 v[112:127], v[44:47], v[36:39], v[112:127]
  v_mfma_f32_32x32x16_bf16 v[128:143], v[32:35], v[48:51], v[128:143]
  s_waitcnt vmcnt(10) lgkmcnt(0)
  s_barrier
  ds_read_b128 v[32:35], v16 offset:16384
  ds_read_b64_tr_b16 v[40:41], v24 offset:16384
  ds_read_b64_tr_b16 v[42:43], v24 offset:17408
  ds_read_b64_tr_b16 v[44:45], v25 offset:16384
  ds_read_b64_tr_b16 v[46:47], v25 offset:17408
  ds_read_b128 v[36:39], v20 offset:16384
  ds_read_b64_tr_b16 v[48:49], v26 offset:4096
  ds_read_b64_tr_b16 v[50:51], v26 offset:4224
  v_mfma_f32_32x32x16_bf16 v[64:79], v[152:155], v[144:147], v[64:79]
  s_add_u32 s98, s3, 4
  s_and_b32 s98, s98, 7
  s_add_u32 m0, s36, 65536
  s_mul_i32 s37, s98, s39
  buffer_load_dwordx4 v10, s[44:47], s37 offen lds
  v_mfma_f32_32x32x16_bf16 v[80:95], v[156:159], v[144:147], v[80:95]
  s_add_u32 m0, s36, 66560
  s_add_u32 s37, s37, s38
  buffer_load_dwordx4 v10, s[44:47], s37 offen lds
  v_mfma_f32_32x32x16_bf16 v[96:111], v[152:155], v[148:151], v[96:111]
  v_mfma_f32_32x32x16_bf16 v[112:127], v[156:159], v[148:151], v[112:127]
  v_mfma_f32_32x32x16_bf16 v[128:143], v[144:147], v[160:163], v[128:143]
  ds_read_b128 v[144:147], v17 offset:16384
  ds_read_b64_tr_b16 v[152:153], v24 offset:20480
  ds_read_b64_tr_b16 v[154:155], v24 offset:21504
  ds_read_b64_tr_b16 v[156:157], v25 offset:20480
  ds_read_b64_tr_b16 v[158:159], v25 offset:21504
  ds_read_b128 v[148:151], v21 offset:16384
  ds_read_b64_tr_b16 v[160:161], v26 offset:4608
  ds_read_b64_tr_b16 v[162:163], v26 offset:4736
  s_waitcnt lgkmcnt(8)
  v_mfma_f32_32x32x16_bf16 v[64:79], v[40:43], v[32:35], v[64:79]
  s_add_u32 m0, s36, 67584
  s_add_u32 s37, s37, s38
  buffer_load_dwordx4 v10, s[44:47], s37 offen lds
  v_mfma_f32_32x32x16_bf16 v[80:95], v[44:47], v[32:35], v[80:95]
  s_add_u32 m0, s36, 68608
  s_add_u32 s37, s37, s38
  buffer_load_dwordx4 v10, s[44:47], s37 offen lds
  v_mfma_f32_32x32x16_bf16 v[96:111], v[40:43], v[36:39], v[96:111]
  v_mfma_f32_32x32x16_bf16 v[112:127], v[44:47], v[36:39], v[112:127]
  v_mfma_f32_32x32x16_bf16 v[128:143], v[32:35], v[48:51], v[128:143]
  ds_read_b128 v[32:35], v18 offset:16384
  ds_read_b64_tr_b16 v[40:41], v24 offset:24576
  ds_read_b64_tr_b16 v[42:43], v24 offset:25600
  ds_read_b64_tr_b16 v[44:45], v25 offset:24576
  ds_read_b64_tr_b16 v[46:47], v25 offset:25600
  ds_read_b128 v[36:39], v22 offset:16384
  ds_read_b64_tr_b16 v[48:49], v26 offset:5120
  ds_read_b64_tr_b16 v[50:51], v26 offset:5248
  s_waitcnt lgkmcnt(8)
  v_mfma_f32_32x32x16_bf16 v[64:79], v[152:155], v[144:147], v[64:79]
  s_add_u32 m0, s60, 131072
  s_lshl_b32 s62, s98, 11
  s_add_u32 s62, s62, s61
  buffer_load_dwordx4 v13, s[48:51], s62 offen lds
  v_mfma_f32_32x32x16_bf16 v[80:95], v[156:159], v[144:147], v[80:95]
  v_mfma_f32_32x32x16_bf16 v[96:111], v[152:155], v[148:151], v[96:111]
  v_mfma_f32_32x32x16_bf16 v[112:127], v[156:159], v[148:151], v[112:127]
  v_mfma_f32_32x32x16_bf16 v[128:143], v[144:147], v[160:163], v[128:143]
  ds_read_b128 v[144:147], v19 offset:16384
  ds_read_b64_tr_b16 v[152:153], v24 offset:28672
  ds_read_b64_tr_b16 v[154:155], v24 offset:29696
  ds_read_b64_tr_b16 v[156:157], v25 offset:28672
  ds_read_b64_tr_b16 v[158:159], v25 offset:29696
  ds_read_b128 v[148:151], v23 offset:16384
  ds_read_b64_tr_b16 v[160:161], v26 offset:5632
  ds_read_b64_tr_b16 v[162:163], v26 offset:5760
  s_waitcnt lgkmcnt(8)
  v_mfma_f32_32x32x16_bf16 v[64:79], v[40:43], v[32:35], v[64:79]
  v_mfma_f32_32x32x16_bf16 v[80:95], v[44:47], v[32:35], v[80:95]
  v_mfma_f32_32x32x16_bf16 v[96:111], v[40:43], v[36:39], v[96:111]
  v_mfma_f32_32x32x16_bf16 v[112:127], v[44:47], v[36:39], v[112:127]
  v_mfma_f32_32x32x16_bf16 v[128:143], v[32:35], v[48:51], v[128:143]
  s_waitcnt vmcnt(10) lgkmcnt(0)
  s_barrier
  ds_read_b128 v[32:35], v16 offset:32768
  ds_read_b64_tr_b16 v[40:41], v24 offset:32768
  ds_read_b64_tr_b16 v[42:43], v24 offset:33792
  ds_read_b64_tr_b16 v[44:45], v25 offset:32768
  ds_read_b64_tr_b16 v[46:47], v25 offset:33792
  ds_read_b128 v[36:39], v20 offset:32768
  ds_read_b64_tr_b16 v[48:49], v26 offset:8192
  ds_read_b64_tr_b16 v[50:51], v26 offset:8320
  v_mfma_f32_32x32x16_bf16 v[64:79], v[152:155], v[144:147], v[64:79]
  s_add_u32 s98, s3, 5
  s_and_b32 s98, s98, 7
  s_add_u32 m0, s36, 81920
  s_mul_i32 s37, s98, s39
  buffer_load_dwordx4 v10, s[44:47], s37 offen lds
  v_mfma_f32_32x32x16_bf16 v[80:95], v[156:159], v[144:147], v[80:95]
  s_add_u32 m0, s36, 82944
  s_add_u32 s37, s37, s38
  buffer_load_dwordx4 v10, s[44:47], s37 offen lds
  v_mfma_f32_32x32x16_bf16 v[96:111], v[152:155], v[148:151], v[96:111]
  v_mfma_f32_32x32x16_bf16 v[112:127], v[156:159], v[148:151], v[112:127]
  v_mfma_f32_32x32x16_bf16 v[128:143], v[144:147], v[160:163], v[128:143]
  ds_read_b128 v[144:147], v17 offset:32768
  ds_read_b64_tr_b16 v[152:153], v24 offset:36864
  ds_read_b64_tr_b16 v[154:155], v24 offset:37888
  ds_read_b64_tr_b16 v[156:157], v25 offset:36864
  ds_read_b64_tr_b16 v[158:159], v25 offset:37888
  ds_read_b128 v[148:151], v21 offset:32768
  ds_read_b64_tr_b16 v[160:161], v26 offset:8704
  ds_read_b64_tr_b16 v[162:163], v26 offset:8832
  s_waitcnt lgkmcnt(8)
  v_mfma_f32_32x32x16_bf16 v[64:79], v[40:43], v[32:35], v[64:79]
  s_add_u32 m0, s36, 83968
  s_add_u32 s37, s37, s38
  buffer_load_dwordx4 v10, s[44:47], s37 offen lds
  v_mfma_f32_32x32x16_bf16 v[80:95], v[44:47], v[32:35], v[80:95]
  s_add_u32 m0, s36, 84992
  s_add_u32 s37, s37, s38
  buffer_load_dwordx4 v10, s[44:47], s37 offen lds
  v_mfma_f32_32x32x16_bf16 v[96:111], v[40:43], v[36:39], v[96:111]
  v_mfma_f32_32x32x16_bf16 v[112:127], v[44:47], v[36:39], v[112:127]
  v_mfma_f32_32x32x16_bf16 v[128:143], v[32:35], v[48:51], v[128:143]
  ds_read_b128 v[32:35], v18 offset:32768
  ds_read_b64_tr_b16 v[40:41], v24 offset:40960
  ds_read_b64_tr_b16 v[42:43], v24 offset:41984
  ds_read_b64_tr_b16 v[44:45], v25 offset:40960
  ds_read_b64_tr_b16 v[46:47], v25 offset:41984
  ds_read_b128 v[36:39], v22 offset:32768
  ds_read_b64_tr_b16 v[48:49], v26 offset:9216
  ds_read_b64_tr_b16 v[50:51], v26 offset:9344
  s_waitcnt lgkmcnt(8)
  v_mfma_f32_32x32x16_bf16 v[64:79], v[152:155], v[144:147], v[64:79]
  s_add_u32 m0, s60, 135168
  s_lshl_b32 s62, s98, 11
  s_add_u32 s62, s62, s61
  buffer_load_dwordx4 v13, s[48:51], s62 offen lds
  v_mfma_f32_32x32x16_bf16 v[80:95], v[156:159], v[144:147], v[80:95]
  v_mfma_f32_32x32x16_bf16 v[96:111], v[152:155], v[148:151], v[96:111]
  v_mfma_f32_32x32x16_bf16 v[112:127], v[156:159], v[148:151], v[112:127]
  v_mfma_f32_32x32x16_bf16 v[128:143], v[144:147], v[160:163], v[128:143]
  ds_read_b128 v[144:147], v19 offset:32768
  ds_read_b64_tr_b16 v[152:153], v24 offset:45056
  ds_read_b64_tr_b16 v[154:155], v24 offset:46080
  ds_read_b64_tr_b16 v[156:157], v25 offset:45056
  ds_read_b64_tr_b16 v[158:159], v25 offset:46080
  ds_read_b128 v[148:151], v23 offset:32768
  ds_read_b64_tr_b16 v[160:161], v26 offset:9728
  ds_read_b64_tr_b16 v[162:163], v26 offset:9856
  s_waitcnt lgkmcnt(8)
  v_mfma_f32_32x32x16_bf16 v[64:79], v[40:43], v[32:35], v[64:79]
  v_mfma_f32_32x32x16_bf16 v[80:95], v[44:47], v[32:35], v[80:95]
  v_mfma_f32_32x32x16_bf16 v[96:111], v[40:43], v[36:39], v[96:111]
  v_mfma_f32_32x32x16_bf16 v[112:127], v[44:47], v[36:39], v[112:127]
  v_mfma_f32_32x32x16_bf16 v[128:143], v[32:35], v[48:51], v[128:143]
  s_waitcnt vmcnt(10) lgkmcnt(0)
  s_barrier
  ds_read_b128 v[32:35], v16 offset:49152
  ds_read_b64_tr_b16 v[40:41], v24 offset:49152
  ds_read_b64_tr_b16 v[42:43], v24 offset:50176
  ds_read_b64_tr_b16 v[44:45], v25 offset:49152
  ds_read_b64_tr_b16 v[46:47], v25 offset:50176
  ds_read_b128 v[36:39], v20 offset:49152
  ds_read_b64_tr_b16 v[48:49], v26 offset:12288
  ds_read_b64_tr_b16 v[50:51], v26 offset:12416
  v_mfma_f32_32x32x16_bf16 v[64:79], v[152:155], v[144:147], v[64:79]
  s_add_u32 s98, s3, 6
  s_and_b32 s98, s98, 7
  s_add_u32 m0, s36, 98304
  s_mul_i32 s37, s98, s39
  buffer_load_dwordx4 v10, s[44:47], s37 offen lds
  v_mfma_f32_32x32x16_bf16 v[80:95], v[156:159], v[144:147], v[80:95]
  s_add_u32 m0, s36, 99328
  s_add_u32 s37, s37, s38
  buffer_load_dwordx4 v10, s[44:47], s37 offen lds
  v_mfma_f32_32x32x16_bf16 v[96:111], v[152:155], v[148:151], v[96:111]
  v_mfma_f32_32x32x16_bf16 v[112:127], v[156:159], v[148:151], v[112:127]
  v_mfma_f32_32x32x16_bf16 v[128:143], v[144:147], v[160:163], v[128:143]
  ds_read_b128 v[144:147], v17 offset:49152
  ds_read_b64_tr_b16 v[152:153], v24 offset:53248
  ds_read_b64_tr_b16 v[154:155], v24 offset:54272
  ds_read_b64_tr_b16 v[156:157], v25 offset:53248
  ds_read_b64_tr_b16 v[158:159], v25 offset:54272
  ds_read_b128 v[148:151], v21 offset:49152
  ds_read_b64_tr_b16 v[160:161], v26 offset:12800
  ds_read_b64_tr_b16 v[162:163], v26 offset:12928
  s_waitcnt lgkmcnt(8)
  v_mfma_f32_32x32x16_bf16 v[64:79], v[40:43], v[32:35], v[64:79]
  s_add_u32 m0, s36, 100352
  s_add_u32 s37, s37, s38
  buffer_load_dwordx4 v10, s[44:47], s37 offen lds
  v_mfma_f32_32x32x16_bf16 v[80:95], v[44:47], v[32:35], v[80:95]
  s_add_u32 m0, s36, 101376
  s_add_u32 s37, s37, s38
  buffer_load_dwordx4 v10, s[44:47], s37 offen lds
  v_mfma_f32_32x32x16_bf16 v[96:111], v[40:43], v[36:39], v[96:111]
  v_mfma_f32_32x32x16_bf16 v[112:127], v[44:47], v[36:39], v[112:127]
  v_mfma_f32_32x32x16_bf16 v[128:143], v[32:35], v[48:51], v[128:143]
  ds_read_b128 v[32:35], v18 offset:49152
  ds_read_b64_tr_b16 v[40:41], v24 offset:57344
  ds_read_b64_tr_b16 v[42:43], v24 offset:58368
  ds_read_b64_tr_b16 v[44:45], v25 offset:57344
  ds_read_b64_tr_b16 v[46:47], v25 offset:58368
  ds_read_b128 v[36:39], v22 offset:49152
  ds_read_b64_tr_b16 v[48:49], v26 offset:13312
  ds_read_b64_tr_b16 v[50:51], v26 offset:13440
  s_waitcnt lgkmcnt(8)
  v_mfma_f32_32x32x16_bf16 v[64:79], v[152:155], v[144:147], v[64:79]
  s_add_u32 m0, s60, 139264
  s_lshl_b32 s62, s98, 11
  s_add_u32 s62, s62, s61
  buffer_load_dwordx4 v13, s[48:51], s62 offen lds
  v_mfma_f32_32x32x16_bf16 v[80:95], v[156:159], v[144:147], v[80:95]
  v_mfma_f32_32x32x16_bf16 v[96:111], v[152:155], v[148:151], v[96:111]
  v_mfma_f32_32x32x16_bf16 v[112:127], v[156:159], v[148:151], v[112:127]
  v_mfma_f32_32x32x16_bf16 v[128:143], v[144:147], v[160:163], v[128:143]
  ds_read_b128 v[144:147], v19 offset:49152
  ds_read_b64_tr_b16 v[152:153], v24 offset:61440
  ds_read_b64_tr_b16 v[154:155], v24 offset:62464
  ds_read_b64_tr_b16 v[156:157], v25 offset:61440
  ds_read_b64_tr_b16 v[158:159], v25 offset:62464
  ds_read_b128 v[148:151], v23 offset:49152
  ds_read_b64_tr_b16 v[160:161], v26 offset:13824
  ds_read_b64_tr_b16 v[162:163], v26 offset:13952
  s_waitcnt lgkmcnt(8)
  v_mfma_f32_32x32x16_bf16 v[64:79], v[40:43], v[32:35], v[64:79]
  v_mfma_f32_32x32x16_bf16 v[80:95], v[44:47], v[32:35], v[80:95]
  v_mfma_f32_32x32x16_bf16 v[96:111], v[40:43], v[36:39], v[96:111]
  v_mfma_f32_32x32x16_bf16 v[112:127], v[44:47], v[36:39], v[112:127]
  v_mfma_f32_32x32x16_bf16 v[128:143], v[32:35], v[48:51], v[128:143]
  s_waitcnt vmcnt(10) lgkmcnt(0)
  s_barrier
  ds_read_b128 v[32:35], v16 offset:0
  ds_read_b64_tr_b16 v[40:41], v24 offset:0
  ds_read_b64_tr_b16 v[42:43], v24 offset:1024
  ds_read_b64_tr_b16 v[44:45], v25 offset:0
  ds_read_b64_tr_b16 v[46:47], v25 offset:1024
  ds_read_b128 v[36:39], v20 offset:0
  ds_read_b64_tr_b16 v[48:49], v26 offset:0
  ds_read_b64_tr_b16 v[50:51], v26 offset:128
  v_mfma_f32_32x32x16_bf16 v[64:79], v[152:155], v[144:147], v[64:79]
  s_add_u32 s98, s3, 7
  s_and_b32 s98, s98, 7
  s_add_u32 m0, s36, 114688
  s_mul_i32 s37, s98, s39
  buffer_load_dwordx4 v10, s[44:47], s37 offen lds
  v_mfma_f32_32x32x16_bf16 v[80:95], v[156:159], v[144:147], v[80:95]
  s_add_u32 m0, s36, 115712
  s_add_u32 s37, s37, s38
  buffer_load_dwordx4 v10, s[44:47], s37 offen lds
  v_mfma_f32_32x32x16_bf16 v[96:111], v[152:155], v[148:151], v[96:111]
  v_mfma_f32_32x32x16_bf16 v[112:127], v[156:159], v[148:151], v[112:127]
  v_mfma_f32_32x32x16_bf16 v[128:143], v[144:147], v[160:163], v[128:143]
  ds_read_b128 v[144:147], v17 offset:0
  ds_read_b64_tr_b16 v[152:153], v24 offset:4096
  ds_read_b64_tr_b16 v[154:155], v24 offset:5120
  ds_read_b64_tr_b16 v[156:157], v25 offset:4096
  ds_read_b64_tr_b16 v[158:159], v25 offset:5120
  ds_read_b128 v[148:151], v21 offset:0
  ds_read_b64_tr_b16 v[160:161], v26 offset:512
  ds_read_b64_tr_b16 v[162:163], v26 offset:640
  s_waitcnt lgkmcnt(8)
  v_mfma_f32_32x32x16_bf16 v[64:79], v[40:43], v[32:35], v[64:79]
  s_add_u32 m0, s36, 116736
  s_add_u32 s37, s37, s38
  buffer_load_dwordx4 v10, s[44:47], s37 offen lds
  v_mfma_f32_32x32x16_bf16 v[80:95], v[44:47], v[32:35], v[80:95]
  s_add_u32 m0, s36, 117760
  s_add_u32 s37, s37, s38
  buffer_load_dwordx4 v10, s[44:47], s37 offen lds
  v_mfma_f32_32x32x16_bf16 v[96:111], v[40:43], v[36:39], v[96:111]
  v_mfma_f32_32x32x16_bf16 v[112:127], v[44:47], v[36:39], v[112:127]
  v_mfma_f32_32x32x16_bf16 v[128:143], v[32:35], v[48:51], v[128:143]
  ds_read_b128 v[32:35], v18 offset:0
  ds_read_b64_tr_b16 v[40:41], v24 offset:8192
  ds_read_b64_tr_b16 v[42:43], v24 offset:9216
  ds_read_b64_tr_b16 v[44:45], v25 offset:8192
  ds_read_b64_tr_b16 v[46:47], v25 offset:9216
  ds_read_b128 v[36:39], v22 offset:0
  ds_read_b64_tr_b16 v[48:49], v26 offset:1024
  ds_read_b64_tr_b16 v[50:51], v26 offset:1152
  s_waitcnt lgkmcnt(8)
  v_mfma_f32_32x32x16_bf16 v[64:79], v[152:155], v[144:147], v[64:79]
  s_add_u32 m0, s60, 143360
  s_lshl_b32 s62, s98, 11
  s_add_u32 s62, s62, s61
  buffer_load_dwordx4 v13, s[48:51], s62 offen lds
  v_mfma_f32_32x32x16_bf16 v[80:95], v[156:159], v[144:147], v[80:95]
  v_mfma_f32_32x32x16_bf16 v[96:111], v[152:155], v[148:151], v[96:111]
  v_mfma_f32_32x32x16_bf16 v[112:127], v[156:159], v[148:151], v[112:127]
  v_mfma_f32_32x32x16_bf16 v[128:143], v[144:147], v[160:163], v[128:143]
  ds_read_b128 v[144:147], v19 offset:0
  ds_read_b64_tr_b16 v[152:153], v24 offset:12288
  ds_read_b64_tr_b16 v[154:155], v24 offset:13312
  ds_read_b64_tr_b16 v[156:157], v25 offset:12288
  ds_read_b64_tr_b16 v[158:159], v25 offset:13312
  ds_read_b128 v[148:151], v23 offset:0
  ds_read_b64_tr_b16 v[160:161], v26 offset:1536
  ds_read_b64_tr_b16 v[162:163], v26 offset:1664
  s_waitcnt lgkmcnt(8)
  v_mfma_f32_32x32x16_bf16 v[64:79], v[40:43], v[32:35], v[64:79]
  v_mfma_f32_32x32x16_bf16 v[80:95], v[44:47], v[32:35], v[80:95]
  v_mfma_f32_32x32x16_bf16 v[96:111], v[40:43], v[36:39], v[96:111]
  v_mfma_f32_32x32x16_bf16 v[112:127], v[44:47], v[36:39], v[112:127]
  v_mfma_f32_32x32x16_bf16 v[128:143], v[32:35], v[48:51], v[128:143]
  s_waitcnt vmcnt(10) lgkmcnt(0)
  s_barrier
  ds_read_b128 v[32:35], v16 offset:16384
  ds_read_b64_tr_b16 v[40:41], v24 offset:16384
  ds_read_b64_tr_b16 v[42:43], v24 offset:17408
  ds_read_b64_tr_b16 v[44:45], v25 offset:16384
  ds_read_b64_tr_b16 v[46:47], v25 offset:17408
  ds_read_b128 v[36:39], v20 offset:16384
  ds_read_b64_tr_b16 v[48:49], v26 offset:4096
  ds_read_b64_tr_b16 v[50:51], v26 offset:4224
  v_mfma_f32_32x32x16_bf16 v[64:79], v[152:155], v[144:147], v[64:79]
  v_mfma_f32_32x32x16_bf16 v[80:95], v[156:159], v[144:147], v[80:95]
  v_mfma_f32_32x32x16_bf16 v[96:111], v[152:155], v[148:151], v[96:111]
  v_mfma_f32_32x32x16_bf16 v[112:127], v[156:159], v[148:151], v[112:127]
  v_mfma_f32_32x32x16_bf16 v[128:143], v[144:147], v[160:163], v[128:143]
  ds_read_b128 v[144:147], v17 offset:16384
  ds_read_b64_tr_b16 v[152:153], v24 offset:20480
  ds_read_b64_tr_b16 v[154:155], v24 offset:21504
  ds_read_b64_tr_b16 v[156:157], v25 offset:20480
  ds_read_b64_tr_b16 v[158:159], v25 offset:21504
  ds_read_b128 v[148:151], v21 offset:16384
  ds_read_b64_tr_b16 v[160:161], v26 offset:4608
  ds_read_b64_tr_b16 v[162:163], v26 offset:4736
  s_waitcnt lgkmcnt(8)
  v_mfma_f32_32x32x16_bf16 v[64:79], v[40:43], v[32:35], v[64:79]
  v_mfma_f32_32x32x16_bf16 v[80:95], v[44:47], v[32:35], v[80:95]
  v_mfma_f32_32x32x16_bf16 v[96:111], v[40:43], v[36:39], v[96:111]
  v_mfma_f32_32x32x16_bf16 v[112:127], v[44:47], v[36:39], v[112:127]
  v_mfma_f32_32x32x16_bf16 v[128:143], v[32:35], v[48:51], v[128:143]
  ds_read_b128 v[32:35], v18 offset:16384
  ds_read_b64_tr_b16 v[40:41], v24 offset:24576
  ds_read_b64_tr_b16 v[42:43], v24 offset:25600
  ds_read_b64_tr_b16 v[44:45], v25 offset:24576
  ds_read_b64_tr_b16 v[46:47], v25 offset:25600
  ds_read_b128 v[36:39], v22 offset:16384
  ds_read_b64_tr_b16 v[48:49], v26 offset:5120
  ds_read_b64_tr_b16 v[50:51], v26 offset:5248
  s_waitcnt lgkmcnt(8)
  v_mfma_f32_32x32x16_bf16 v[64:79], v[152:155], v[144:147], v[64:79]
  v_mfma_f32_32x32x16_bf16 v[80:95], v[156:159], v[144:147], v[80:95]
  v_mfma_f32_32x32x16_bf16 v[96:111], v[152:155], v[148:151], v[96:111]
  v_mfma_f32_32x32x16_bf16 v[112:127], v[156:159], v[148:151], v[112:127]
  v_mfma_f32_32x32x16_bf16 v[128:143], v[144:147], v[160:163], v[128:143]
  ds_read_b128 v[144:147], v19 offset:16384
  ds_read_b64_tr_b16 v[152:153], v24 offset:28672
  ds_read_b64_tr_b16 v[154:155], v24 offset:29696
  ds_read_b64_tr_b16 v[156:157], v25 offset:28672
  ds_read_b64_tr_b16 v[158:159], v25 offset:29696
  ds_read_b128 v[148:151], v23 offset:16384
  ds_read_b64_tr_b16 v[160:161], v26 offset:5632
  ds_read_b64_tr_b16 v[162:163], v26 offset:5760
  s_waitcnt lgkmcnt(8)
  v_mfma_f32_32x32x16_bf16 v[64:79], v[40:43], v[32:35], v[64:79]
  v_mfma_f32_32x32x16_bf16 v[80:95], v[44:47], v[32:35], v[80:95]
  v_mfma_f32_32x32x16_bf16 v[96:111], v[40:43], v[36:39], v[96:111]
  v_mfma_f32_32x32x16_bf16 v[112:127], v[44:47], v[36:39], v[112:127]
  v_mfma_f32_32x32x16_bf16 v[128:143], v[32:35], v[48:51], v[128:143]
  s_waitcnt vmcnt(5) lgkmcnt(0)
  s_barrier
  ds_read_b128 v[32:35], v16 offset:32768
  ds_read_b64_tr_b16 v[40:41], v24 offset:32768
  ds_read_b64_tr_b16 v[42:43], v24 offset:33792
  ds_read_b64_tr_b16 v[44:45], v25 offset:32768
  ds_read_b64_tr_b16 v[46:47], v25 offset:33792
  ds_read_b128 v[36:39], v20 offset:32768
  ds_read_b64_tr_b16 v[48:49], v26 offset:8192
  ds_read_b64_tr_b16 v[50:51], v26 offset:8320
  v_mfma_f32_32x32x16_bf16 v[64:79], v[152:155], v[144:147], v[64:79]
  v_mfma_f32_32x32x16_bf16 v[80:95], v[156:159], v[144:147], v[80:95]
  v_mfma_f32_32x32x16_bf16 v[96:111], v[152:155], v[148:151], v[96:111]
  v_mfma_f32_32x32x16_bf16 v[112:127], v[156:159], v[148:151], v[112:127]
  v_mfma_f32_32x32x16_bf16 v[128:143], v[144:147], v[160:163], v[128:143]
  ds_read_b128 v[144:147], v17 offset:32768
  ds_read_b64_tr_b16 v[152:153], v24 offset:36864
  ds_read_b64_tr_b16 v[154:155], v24 offset:37888
  ds_read_b64_tr_b16 v[156:157], v25 offset:36864
  ds_read_b64_tr_b16 v[158:159], v25 offset:37888
  ds_read_b128 v[148:151], v21 offset:32768
  ds_read_b64_tr_b16 v[160:161], v26 offset:8704
  ds_read_b64_tr_b16 v[162:163], v26 offset:8832
  s_waitcnt lgkmcnt(8)
  v_mfma_f32_32x32x16_bf16 v[64:79], v[40:43], v[32:35], v[64:79]
  v_mfma_f32_32x32x16_bf16 v[80:95], v[44:47], v[32:35], v[80:95]
  v_mfma_f32_32x32x16_bf16 v[96:111], v[40:43], v[36:39], v[96:111]
  v_mfma_f32_32x32x16_bf16 v[112:127], v[44:47], v[36:39], v[112:127]
  v_mfma_f32_32x32x16_bf16 v[128:143], v[32:35], v[48:51], v[128:143]
  ds_read_b128 v[32:35], v18 offset:32768
  ds_read_b64_tr_b16 v[40:41], v24 offset:40960
  ds_read_b64_tr_b16 v[42:43], v24 offset:41984
  ds_read_b64_tr_b16 v[44:45], v25 offset:40960
  ds_read_b64_tr_b16 v[46:47], v25 offset:41984
  ds_read_b128 v[36:39], v22 offset:32768
  ds_read_b64_tr_b16 v[48:49], v26 offset:9216
  ds_read_b64_tr_b16 v[50:51], v26 offset:9344
  s_waitcnt lgkmcnt(8)
  v_mfma_f32_32x32x16_bf16 v[64:79], v[152:155], v[144:147], v[64:79]
  v_mfma_f32_32x32x16_bf16 v[80:95], v[156:159], v[144:147], v[80:95]
  v_mfma_f32_32x32x16_bf16 v[96:111], v[152:155], v[148:151], v[96:111]
  v_mfma_f32_32x32x16_bf16 v[112:127], v[156:159], v[148:151], v[112:127]
  v_mfma_f32_32x32x16_bf16 v[128:143], v[144:147], v[160:163], v[128:143]
  ds_read_b128 v[144:147], v19 offset:32768
  ds_read_b64_tr_b16 v[152:153], v24 offset:45056
  ds_read_b64_tr_b16 v[154:155], v24 offset:46080
  ds_read_b64_tr_b16 v[156:157], v25 offset:45056
  ds_read_b64_tr_b16 v[158:159], v25 offset:46080
  ds_read_b128 v[148:151], v23 offset:32768
  ds_read_b64_tr_b16 v[160:161], v26 offset:9728
  ds_read_b64_tr_b16 v[162:163], v26 offset:9856
  s_waitcnt lgkmcnt(8)
  v_mfma_f32_32x32x16_bf16 v[64:79], v[40:43], v[32:35], v[64:79]
  v_mfma_f32_32x32x16_bf16 v[80:95], v[44:47], v[32:35], v[80:95]
  v_mfma_f32_32x32x16_bf16 v[96:111], v[40:43], v[36:39], v[96:111]
  v_mfma_f32_32x32x16_bf16 v[112:127], v[44:47], v[36:39], v[112:127]
  v_mfma_f32_32x32x16_bf16 v[128:143], v[32:35], v[48:51], v[128:143]
  s_waitcnt vmcnt(0) lgkmcnt(0)
  s_barrier
  ds_read_b128 v[32:35], v16 offset:49152
  ds_read_b64_tr_b16 v[40:41], v24 offset:49152
  ds_read_b64_tr_b16 v[42:43], v24 offset:50176
  ds_read_b64_tr_b16 v[44:45], v25 offset:49152
  ds_read_b64_tr_b16 v[46:47], v25 offset:50176
  ds_read_b128 v[36:39], v20 offset:49152
  ds_read_b64_tr_b16 v[48:49], v26 offset:12288
  ds_read_b64_tr_b16 v[50:51], v26 offset:12416
  v_mfma_f32_32x32x16_bf16 v[64:79], v[152:155], v[144:147], v[64:79]
  v_mfma_f32_32x32x16_bf16 v[80:95], v[156:159], v[144:147], v[80:95]
  v_mfma_f32_32x32x16_bf16 v[96:111], v[152:155], v[148:151], v[96:111]
  v_mfma_f32_32x32x16_bf16 v[112:127], v[156:159], v[148:151], v[112:127]
  v_mfma_f32_32x32x16_bf16 v[128:143], v[144:147], v[160:163], v[128:143]
  ds_read_b128 v[144:147], v17 offset:49152
  ds_read_b64_tr_b16 v[152:153], v24 offset:53248
  ds_read_b64_tr_b16 v[154:155], v24 offset:54272
  ds_read_b64_tr_b16 v[156:157], v25 offset:53248
  ds_read_b64_tr_b16 v[158:159], v25 offset:54272
  ds_read_b128 v[148:151], v21 offset:49152
  ds_read_b64_tr_b16 v[160:161], v26 offset:12800
  ds_read_b64_tr_b16 v[162:163], v26 offset:12928
  s_waitcnt lgkmcnt(8)
  v_mfma_f32_32x32x16_bf16 v[64:79], v[40:43], v[32:35], v[64:79]
  v_mfma_f32_32x32x16_bf16 v[80:95], v[44:47], v[32:35], v[80:95]
  v_mfma_f32_32x32x16_bf16 v[96:111], v[40:43], v[36:39], v[96:111]
  v_mfma_f32_32x32x16_bf16 v[112:127], v[44:47], v[36:39], v[112:127]
  v_mfma_f32_32x32x16_bf16 v[128:143], v[32:35], v[48:51], v[128:143]
  ds_read_b128 v[32:35], v18 offset:49152
  ds_read_b64_tr_b16 v[40:41], v24 offset:57344
  ds_read_b64_tr_b16 v[42:43], v24 offset:58368
  ds_read_b64_tr_b16 v[44:45], v25 offset:57344
  ds_read_b64_tr_b16 v[46:47], v25 offset:58368
  ds_read_b128 v[36:39], v22 offset:49152
  ds_read_b64_tr_b16 v[48:49], v26 offset:13312
  ds_read_b64_tr_b16 v[50:51], v26 offset:13440
  s_waitcnt lgkmcnt(8)
  v_mfma_f32_32x32x16_bf16 v[64:79], v[152:155], v[144:147], v[64:79]
  v_mfma_f32_32x32x16_bf16 v[80:95], v[156:159], v[144:147], v[80:95]
  v_mfma_f32_32x32x16_bf16 v[96:111], v[152:155], v[148:151], v[96:111]
  v_mfma_f32_32x32x16_bf16 v[112:127], v[156:159], v[148:151], v[112:127]
  v_mfma_f32_32x32x16_bf16 v[128:143], v[144:147], v[160:163], v[128:143]
  ds_read_b128 v[144:147], v19 offset:49152
  ds_read_b64_tr_b16 v[152:153], v24 offset:61440
  ds_read_b64_tr_b16 v[154:155], v24 offset:62464
  ds_read_b64_tr_b16 v[156:157], v25 offset:61440
  ds_read_b64_tr_b16 v[158:159], v25 offset:62464
  ds_read_b128 v[148:151], v23 offset:49152
  ds_read_b64_tr_b16 v[160:161], v26 offset:13824
  ds_read_b64_tr_b16 v[162:163], v26 offset:13952
  s_waitcnt lgkmcnt(8)
  v_mfma_f32_32x32x16_bf16 v[64:79], v[40:43], v[32:35], v[64:79]
  v_mfma_f32_32x32x16_bf16 v[80:95], v[44:47], v[32:35], v[80:95]
  v_mfma_f32_32x32x16_bf16 v[96:111], v[40:43], v[36:39], v[96:111]
  v_mfma_f32_32x32x16_bf16 v[112:127], v[44:47], v[36:39], v[112:127]
  v_mfma_f32_32x32x16_bf16 v[128:143], v[32:35], v[48:51], v[128:143]
  s_waitcnt vmcnt(0) lgkmcnt(0)
  s_barrier
  v_mfma_f32_32x32x16_bf16 v[64:79], v[152:155], v[144:147], v[64:79]
  v_mfma_f32_32x32x16_bf16 v[80:95], v[156:159], v[144:147], v[80:95]
  v_mfma_f32_32x32x16_bf16 v[96:111], v[152:155], v[148:151], v[96:111]
  v_mfma_f32_32x32x16_bf16 v[112:127], v[156:159], v[148:151], v[112:127]
  v_mfma_f32_32x32x16_bf16 v[128:143], v[144:147], v[160:163], v[128:143]
  s_nop 7
  s_nop 3
  v_cvt_pk_bf16_f32 v64, v64, v65
  v_cvt_pk_bf16_f32 v65, v66, v67
  v_cvt_pk_bf16_f32 v66, v68, v69
  v_cvt_pk_bf16_f32 v67, v70, v71
  v_cvt_pk_bf16_f32 v68, v72, v73
  v_cvt_pk_bf16_f32 v69, v74, v75
  v_cvt_pk_bf16_f32 v70, v76, v77
  v_cvt_pk_bf16_f32 v71, v78, v79
  buffer_store_dwordx4 v[64:67], v13, s[56:59], s63 offen offset:0 sc1
  buffer_store_dwordx4 v[68:71], v13, s[56:59], s63 offen offset:1024 sc1
  v_cvt_pk_bf16_f32 v80, v80, v81
  v_cvt_pk_bf16_f32 v81, v82, v83
  v_cvt_pk_bf16_f32 v82, v84, v85
  v_cvt_pk_bf16_f32 v83, v86, v87
  v_cvt_pk_bf16_f32 v84, v88, v89
  v_cvt_pk_bf16_f32 v85, v90, v91
  v_cvt_pk_bf16_f32 v86, v92, v93
  v_cvt_pk_bf16_f32 v87, v94, v95
  buffer_store_dwordx4 v[80:83], v13, s[56:59], s63 offen offset:2048 sc1
  buffer_store_dwordx4 v[84:87], v13, s[56:59], s63 offen offset:3072 sc1
  v_cvt_pk_bf16_f32 v96, v96, v97
  v_cvt_pk_bf16_f32 v97, v98, v99
  v_cvt_pk_bf16_f32 v98, v100, v101
  v_cvt_pk_bf16_f32 v99, v102, v103
  v_cvt_pk_bf16_f32 v100, v104, v105
  v_cvt_pk_bf16_f32 v101, v106, v107
  v_cvt_pk_bf16_f32 v102, v108, v109
  v_cvt_pk_bf16_f32 v103, v110, v111
  buffer_store_dwordx4 v[96:99], v13, s[56:59], s64 offen offset:0 sc1
  buffer_store_dwordx4 v[100:103], v13, s[56:59], s64 offen offset:1024 sc1
  v_cvt_pk_bf16_f32 v112, v112, v113
  v_cvt_pk_bf16_f32 v113, v114, v115
  v_cvt_pk_bf16_f32 v114, v116, v117
  v_cvt_pk_bf16_f32 v115, v118, v119
  v_cvt_pk_bf16_f32 v116, v120, v121
  v_cvt_pk_bf16_f32 v117, v122, v123
  v_cvt_pk_bf16_f32 v118, v124, v125
  v_cvt_pk_bf16_f32 v119, v126, v127
  buffer_store_dwordx4 v[112:115], v13, s[56:59], s64 offen offset:2048 sc1
  buffer_store_dwordx4 v[116:119], v13, s[56:59], s64 offen offset:3072 sc1
  s_lshl_b32 s34, s23, 2
  s_add_u32 s34, s34, s25
  s_cmp_lt_u32 s34, 2
  s_cbranch_scc0 K1_SIG
  v_cvt_pk_bf16_f32 v128, v128, v129
  v_cvt_pk_bf16_f32 v129, v130, v131
  v_cvt_pk_bf16_f32 v130, v132, v133
  v_cvt_pk_bf16_f32 v131, v134, v135
  v_cvt_pk_bf16_f32 v132, v136, v137
  v_cvt_pk_bf16_f32 v133, v138, v139
  v_cvt_pk_bf16_f32 v134, v140, v141
  v_cvt_pk_bf16_f32 v135, v142, v143
  v_bfe_u32 v3, v0, 4, 1
  v_cmp_eq_u32 vcc, 1, v3
  v_and_b32 v2, 15, v0
  v_lshrrev_b32 v4, 5, v0
  v_lshl_add_u32 v2, v4, 4, v2
  v_lshl_add_u32 v2, v3, 5, v2
  v_lshlrev_b32 v2, 4, v2
  v_cndmask_b32 v128, v128, v132, vcc
  v_cndmask_b32 v129, v129, v133, vcc
  v_cndmask_b32 v130, v130, v134, vcc
  v_cndmask_b32 v131, v131, v135, vcc
  s_add_u32 s66, s66, 4259840
  buffer_store_dwordx4 v[128:131], v2, s[56:59], s66 offen sc1
  s_branch K1_SIG
K1_KV:
  v_and_b32 v2, 15, v0
  v_lshrrev_b32 v3, 5, v0
  v_lshl_add_u32 v2, v3, 6, v2
  v_lshlrev_b32 v14, 1, v2
  s_lshl_b32 s34, s32, 2
  s_lshl_b32 s35, s27, 1
  s_add_u32 s65, s34, s35
  s_lshl_b32 s34, s65, 9
  s_add_u32 s35, s34, 512
  s_add_u32 s98, s3, 0
  s_and_b32 s98, s98, 7
  s_add_u32 m0, s36, 65536
  s_mul_i32 s37, s98, s39
  buffer_load_dwordx4 v10, s[44:47], s37 offen lds
  s_add_u32 m0, s36, 66560
  s_add_u32 s37, s37, s38
  buffer_load_dwordx4 v10, s[44:47], s37 offen lds
  s_add_u32 m0, s36, 67584
  s_add_u32 s37, s37, s38
  buffer_load_dwordx4 v10, s[44:47], s37 offen lds
  s_add_u32 m0, s36, 68608
  s_add_u32 s37, s37, s38
  buffer_load_dwordx4 v10, s[44:47], s37 offen lds
  s_add_u32 s98, s3, 1
  s_and_b32 s98, s98, 7
  s_add_u32 m0, s36, 81920
  s_mul_i32 s37, s98, s39
  buffer_load_dwordx4 v10, s[44:47], s37 offen lds
  s_add_u32 m0, s36, 82944
  s_add_u32 s37, s37, s38
  buffer_load_dwordx4 v10, s[44:47], s37 offen lds
  s_add_u32 m0, s36, 83968
  s_add_u32 s37, s37, s38
  buffer_load_dwordx4 v10, s[44:47], s37 offen lds
  s_add_u32 m0, s36, 84992
  s_add_u32 s37, s37, s38
  buffer_load_dwordx4 v10, s[44:47], s37 offen lds
  s_add_u32 s98, s3, 2
  s_and_b32 s98, s98, 7
  s_add_u32 m0, s36, 98304
  s_mul_i32 s37, s98, s39
  buffer_load_dwordx4 v10, s[44:47], s37 offen lds
  s_add_u32 m0, s36, 99328
  s_add_u32 s37, s37, s38
  buffer_load_dwordx4 v10, s[44:47], s37 offen lds
  s_add_u32 m0, s36, 100352
  s_add_u32 s37, s37, s38
  buffer_load_dwordx4 v10, s[44:47], s37 offen lds
  s_add_u32 m0, s36, 101376
  s_add_u32 s37, s37, s38
  buffer_load_dwordx4 v10, s[44:47], s37 offen lds
  s_add_u32 s98, s3, 3
  s_and_b32 s98, s98, 7
  s_add_u32 m0, s36, 114688
  s_mul_i32 s37, s98, s39
  buffer_load_dwordx4 v10, s[44:47], s37 offen lds
  s_add_u32 m0, s36, 115712
  s_add_u32 s37, s37, s38
  buffer_load_dwordx4 v10, s[44:47], s37 offen lds
  s_add_u32 m0, s36, 116736
  s_add_u32 s37, s37, s38
  buffer_load_dwordx4 v10, s[44:47], s37 offen lds
  s_add_u32 m0, s36, 117760
  s_add_u32 s37, s37, s38
  buffer_load_dwordx4 v10, s[44:47], s37 offen lds
  s_mov_b32 s18, s34
  s_mov_b32 s19, s35
  s_mov_b32 s25, 0
  v_and_b32 v2, 31, v0
  v_lshrrev_b32 v3, 5, v0
  v_bfe_u32 v4, v0, 1, 3
  v_xor_b32 v4, v4, v3
  v_lshlrev_b32 v4, 4, v4
  v_lshl_add_u32 v4, v2, 7, v4
  s_lshl_b32 s34, s26, 13
  s_and_b32 s35, s25, 1
  s_lshl_b32 s35, s35, 12
  s_add_u32 s34, s34, s35
  v_add_u32 v16, s34, v4
  v_xor_b32 v17, 32, v16
  v_xor_b32 v18, 64, v16
  v_xor_b32 v19, 96, v16
  v_xor_b32 v20, 4096, v16
  v_xor_b32 v21, 4096, v17
  v_xor_b32 v22, 4096, v18
  v_xor_b32 v23, 4096, v19
  v_bfe_u32 v4, v0, 2, 2
  v_lshl_add_u32 v5, v3, 3, v4
  v_bfe_u32 v6, v0, 4, 1
  v_bfe_u32 v7, v0, 1, 1
  v_lshl_add_u32 v6, v6, 1, v7
  s_lshl_b32 s34, s27, 3
  v_add_u32 v6, s34, v6
  v_lshlrev_b32 v7, 2, v4
  v_xor_b32 v6, v6, v7
  v_lshlrev_b32 v6, 4, v6
  v_and_b32 v7, 1, v0
  v_lshl_add_u32 v6, v7, 3, v6
  v_lshl_add_u32 v6, v5, 8, v6
  v_add_u32 v24, 65536, v6
  v_xor_b32 v25, 64, v24
  v_and_b32 v7, 3, v0
  v_lshlrev_b32 v7, 3, v7
  v_lshl_add_u32 v7, v5, 5, v7
  s_lshl_b32 s34, s27, 11
  s_add_u32 s34, s34, 131072
  v_add_u32 v26, s34, v7
  v_and_b32 v2, 31, v0
  v_lshlrev_b32 v3, 2, v3
  v_sub_u32 v2, v2, v3
  v_mov_b32 v4, 0x3f80
  v_mov_b32 v5, 0x3f800000
  v_cmp_eq_u32 vcc, 0, v2
  v_cmp_eq_u32 s[68:69], 1, v2
  s_nop 1
  v_cndmask_b32 v6, 0, v4, vcc
  v_cndmask_b32 v176, v6, v5, s[68:69]
  v_cmp_eq_u32 vcc, 2, v2
  v_cmp_eq_u32 s[68:69], 3, v2
  s_nop 1
  v_cndmask_b32 v6, 0, v4, vcc
  v_cndmask_b32 v177, v6, v5, s[68:69]
  v_cmp_eq_u32 vcc, 8, v2
  v_cmp_eq_u32 s[68:69], 9, v2
  s_nop 1
  v_cndmask_b32 v6, 0, v4, vcc
  v_cndmask_b32 v178, v6, v5, s[68:69]
  v_cmp_eq_u32 vcc, 10, v2
  v_cmp_eq_u32 s[68:69], 11, v2
  s_nop 1
  v_cndmask_b32 v6, 0, v4, vcc
  v_cndmask_b32 v179, v6, v5, s[68:69]
  v_cmp_eq_u32 vcc, 16, v2
  v_cmp_eq_u32 s[68:69], 17, v2
  s_nop 1
  v_cndmask_b32 v6, 0, v4, vcc
  v_cndmask_b32 v180, v6, v5, s[68:69]
  v_cmp_eq_u32 vcc, 18, v2
  v_cmp_eq_u32 s[68:69], 19, v2
  s_nop 1
  v_cndmask_b32 v6, 0, v4, vcc
  v_cndmask_b32 v181, v6, v5, s[68:69]
  v_cmp_eq_u32 vcc, 24, v2
  v_cmp_eq_u32 s[68:69], 25, v2
  s_nop 1
  v_cndmask_b32 v6, 0, v4, vcc
  v_cndmask_b32 v182, v6, v5, s[68:69]
  v_cmp_eq_u32 vcc, 26, v2
  v_cmp_eq_u32 s[68:69], 27, v2
  s_nop 1
  v_cndmask_b32 v6, 0, v4, vcc
  v_cndmask_b32 v183, v6, v5, s[68:69]
  v_bfe_u32 v2, v0, 4, 1
  v_cmp_eq_u32 s[70:71], 1, v2
  v_mul_u32_u24 v15, 0x8000, v2
  v_lshl_or_b32 v15, v15, 16, v15
  s_mov_b32 s72, 1069066811
  s_mov_b32 s73, 1069066811
  s_waitcnt vmcnt(12)
  s_barrier
  ds_read_b128 v[32:35], v16 offset:0
  ds_read_b64_tr_b16 v[40:41], v24 offset:0
  ds_read_b64_tr_b16 v[42:43], v24 offset:1024
  ds_read_b64_tr_b16 v[44:45], v25 offset:0
  ds_read_b64_tr_b16 v[46:47], v25 offset:1024
  ds_read_b128 v[36:39], v20 offset:0
  ds_read_b128 v[144:147], v17 offset:0
  ds_read_b64_tr_b16 v[152:153], v24 offset:4096
  ds_read_b64_tr_b16 v[154:155], v24 offset:5120
  ds_read_b64_tr_b16 v[156:157], v25 offset:4096
  ds_read_b64_tr_b16 v[158:159], v25 offset:5120
  ds_read_b128 v[148:151], v21 offset:0
  s_waitcnt lgkmcnt(6)
  v_mfma_f32_32x32x16_bf16 v[64:79], v[40:43], v[32:35], 0
  v_mfma_f32_32x32x16_bf16 v[80:95], v[32:35], v[44:47], 0
  v_mfma_f32_32x32x16_bf16 v[96:111], v[40:43], v[36:39], 0
  v_mfma_f32_32x32x16_bf16 v[112:127], v[36:39], v[44:47], 0
  ds_read_b128 v[32:35], v18 offset:0
  ds_read_b64_tr_b16 v[40:41], v24 offset:8192
  ds_read_b64_tr_b16 v[42:43], v24 offset:9216
  ds_read_b64_tr_b16 v[44:45], v25 offset:8192
  ds_read_b64_tr_b16 v[46:47], v25 offset:9216
  ds_read_b128 v[36:39], v22 offset:0
  s_waitcnt lgkmcnt(6)
  v_mfma_f32_32x32x16_bf16 v[64:79], v[152:155], v[144:147], v[64:79]
  v_mfma_f32_32x32x16_bf16 v[80:95], v[144:147], v[156:159], v[80:95]
  v_mfma_f32_32x32x16_bf16 v[96:111], v[152:155], v[148:151], v[96:111]
  v_mfma_f32_32x32x16_bf16 v[112:127], v[148:151], v[156:159], v[112:127]
  ds_read_b128 v[144:147], v19 offset:0
  ds_read_b64_tr_b16 v[152:153], v24 offset:12288
  ds_read_b64_tr_b16 v[154:155], v24 offset:13312
  ds_read_b64_tr_b16 v[156:157], v25 offset:12288
  ds_read_b64_tr_b16 v[158:159], v25 offset:13312
  ds_read_b128 v[148:151], v23 offset:0
  s_waitcnt lgkmcnt(6)
  v_mfma_f32_32x32x16_bf16 v[64:79], v[40:43], v[32:35], v[64:79]
  v_mfma_f32_32x32x16_bf16 v[80:95], v[32:35], v[44:47], v[80:95]
  v_mfma_f32_32x32x16_bf16 v[96:111], v[40:43], v[36:39], v[96:111]
  v_mfma_f32_32x32x16_bf16 v[112:127], v[36:39], v[44:47], v[112:127]
  s_waitcnt vmcnt(8) lgkmcnt(0)
  s_barrier
  ds_read_b128 v[32:35], v16 offset:16384
  ds_read_b64_tr_b16 v[40:41], v24 offset:16384
  ds_read_b64_tr_b16 v[42:43], v24 offset:17408
  ds_read_b64_tr_b16 v[44:45], v25 offset:16384
  ds_read_b64_tr_b16 v[46:47], v25 offset:17408
  ds_read_b128 v[36:39], v20 offset:16384
  v_mfma_f32_32x32x16_bf16 v[64:79], v[152:155], v[144:147], v[64:79]
  s_add_u32 s98, s3, 4
  s_and_b32 s98, s98, 7
  s_add_u32 m0, s36, 65536
  s_mul_i32 s37, s98, s39
  buffer_load_dwordx4 v10, s[44:47], s37 offen lds
  v_mfma_f32_32x32x16_bf16 v[80:95], v[144:147], v[156:159], v[80:95]
  s_add_u32 m0, s36, 66560
  s_add_u32 s37, s37, s38
  buffer_load_dwordx4 v10, s[44:47], s37 offen lds
  v_mfma_f32_32x32x16_bf16 v[96:111], v[152:155], v[148:151], v[96:111]
  v_mfma_f32_32x32x16_bf16 v[112:127], v[148:151], v[156:159], v[112:127]
  ds_read_b128 v[144:147], v17 offset:16384
  ds_read_b64_tr_b16 v[152:153], v24 offset:20480
  ds_read_b64_tr_b16 v[154:155], v24 offset:21504
  ds_read_b64_tr_b16 v[156:157], v25 offset:20480
  ds_read_b64_tr_b16 v[158:159], v25 offset:21504
  ds_read_b128 v[148:151], v21 offset:16384
  s_waitcnt lgkmcnt(6)
  v_mfma_f32_32x32x16_bf16 v[64:79], v[40:43], v[32:35], v[64:79]
  s_add_u32 m0, s36, 67584
  s_add_u32 s37, s37, s38
  buffer_load_dwordx4 v10, s[44:47], s37 offen lds
  v_mfma_f32_32x32x16_bf16 v[80:95], v[32:35], v[44:47], v[80:95]
  s_add_u32 m0, s36, 68608
  s_add_u32 s37, s37, s38
  buffer_load_dwordx4 v10, s[44:47], s37 offen lds
  v_mfma_f32_32x32x16_bf16 v[96:111], v[40:43], v[36:39], v[96:111]
  v_mfma_f32_32x32x16_bf16 v[112:127], v[36:39], v[44:47], v[112:127]
  ds_read_b128 v[32:35], v18 offset:16384
  ds_read_b64_tr_b16 v[40:41], v24 offset:24576
  ds_read_b64_tr_b16 v[42:43], v24 offset:25600
  ds_read_b64_tr_b16 v[44:45], v25 offset:24576
  ds_read_b64_tr_b16 v[46:47], v25 offset:25600
  ds_read_b128 v[36:39], v22 offset:16384
  s_waitcnt lgkmcnt(6)
  v_mfma_f32_32x32x16_bf16 v[64:79], v[152:155], v[144:147], v[64:79]
  v_mfma_f32_32x32x16_bf16 v[80:95], v[144:147], v[156:159], v[80:95]
  v_mfma_f32_32x32x16_bf16 v[96:111], v[152:155], v[148:151], v[96:111]
  v_mfma_f32_32x32x16_bf16 v[112:127], v[148:151], v[156:159], v[112:127]
  ds_read_b128 v[144:147], v19 offset:16384
  ds_read_b64_tr_b16 v[152:153], v24 offset:28672
  ds_read_b64_tr_b16 v[154:155], v24 offset:29696
  ds_read_b64_tr_b16 v[156:157], v25 offset:28672
  ds_read_b64_tr_b16 v[158:159], v25 offset:29696
  ds_read_b128 v[148:151], v23 offset:16384
  s_waitcnt lgkmcnt(6)
  v_mfma_f32_32x32x16_bf16 v[64:79], v[40:43], v[32:35], v[64:79]
  v_mfma_f32_32x32x16_bf16 v[80:95], v[32:35], v[44:47], v[80:95]
  v_mfma_f32_32x32x16_bf16 v[96:111], v[40:43], v[36:39], v[96:111]
  v_mfma_f32_32x32x16_bf16 v[112:127], v[36:39], v[44:47], v[112:127]
  s_waitcnt vmcnt(8) lgkmcnt(0)
  s_barrier
  ds_read_b128 v[32:35], v16 offset:32768
  ds_read_b64_tr_b16 v[40:41], v24 offset:32768
  ds_read_b64_tr_b16 v[42:43], v24 offset:33792
  ds_read_b64_tr_b16 v[44:45], v25 offset:32768
  ds_read_b64_tr_b16 v[46:47], v25 offset:33792
  ds_read_b128 v[36:39], v20 offset:32768
  v_mfma_f32_32x32x16_bf16 v[64:79], v[152:155], v[144:147], v[64:79]
  s_add_u32 s98, s3, 5
  s_and_b32 s98, s98, 7
  s_add_u32 m0, s36, 81920
  s_mul_i32 s37, s98, s39
  buffer_load_dwordx4 v10, s[44:47], s37 offen lds
  v_mfma_f32_32x32x16_bf16 v[80:95], v[144:147], v[156:159], v[80:95]
  s_add_u32 m0, s36, 82944
  s_add_u32 s37, s37, s38
  buffer_load_dwordx4 v10, s[44:47], s37 offen lds
  v_mfma_f32_32x32x16_bf16 v[96:111], v[152:155], v[148:151], v[96:111]
  v_mfma_f32_32x32x16_bf16 v[112:127], v[148:151], v[156:159], v[112:127]
  ds_read_b128 v[144:147], v17 offset:32768
  ds_read_b64_tr_b16 v[152:153], v24 offset:36864
  ds_read_b64_tr_b16 v[154:155], v24 offset:37888
  ds_read_b64_tr_b16 v[156:157], v25 offset:36864
  ds_read_b64_tr_b16 v[158:159], v25 offset:37888
  ds_read_b128 v[148:151], v21 offset:32768
  s_waitcnt lgkmcnt(6)
  v_mfma_f32_32x32x16_bf16 v[64:79], v[40:43], v[32:35], v[64:79]
  s_add_u32 m0, s36, 83968
  s_add_u32 s37, s37, s38
  buffer_load_dwordx4 v10, s[44:47], s37 offen lds
  v_mfma_f32_32x32x16_bf16 v[80:95], v[32:35], v[44:47], v[80:95]
  s_add_u32 m0, s36, 84992
  s_add_u32 s37, s37, s38
  buffer_load_dwordx4 v10, s[44:47], s37 offen lds
  v_mfma_f32_32x32x16_bf16 v[96:111], v[40:43], v[36:39], v[96:111]
  v_mfma_f32_32x32x16_bf16 v[112:127], v[36:39], v[44:47], v[112:127]
  ds_read_b128 v[32:35], v18 offset:32768
  ds_read_b64_tr_b16 v[40:41], v24 offset:40960
  ds_read_b64_tr_b16 v[42:43], v24 offset:41984
  ds_read_b64_tr_b16 v[44:45], v25 offset:40960
  ds_read_b64_tr_b16 v[46:47], v25 offset:41984
  ds_read_b128 v[36:39], v22 offset:32768
  s_waitcnt lgkmcnt(6)
  v_mfma_f32_32x32x16_bf16 v[64:79], v[152:155], v[144:147], v[64:79]
  v_mfma_f32_32x32x16_bf16 v[80:95], v[144:147], v[156:159], v[80:95]
  v_mfma_f32_32x32x16_bf16 v[96:111], v[152:155], v[148:151], v[96:111]
  v_mfma_f32_32x32x16_bf16 v[112:127], v[148:151], v[156:159], v[112:127]
  ds_read_b128 v[144:147], v19 offset:32768
  ds_read_b64_tr_b16 v[152:153], v24 offset:45056
  ds_read_b64_tr_b16 v[154:155], v24 offset:46080
  ds_read_b64_tr_b16 v[156:157], v25 offset:45056
  ds_read_b64_tr_b16 v[158:159], v25 offset:46080
  ds_read_b128 v[148:151], v23 offset:32768
  s_waitcnt lgkmcnt(6)
  v_mfma_f32_32x32x16_bf16 v[64:79], v[40:43], v[32:35], v[64:79]
  v_mfma_f32_32x32x16_bf16 v[80:95], v[32:35], v[44:47], v[80:95]
  v_mfma_f32_32x32x16_bf16 v[96:111], v[40:43], v[36:39], v[96:111]
  v_mfma_f32_32x32x16_bf16 v[112:127], v[36:39], v[44:47], v[112:127]
  s_waitcnt vmcnt(8) lgkmcnt(0)
  s_barrier
  ds_read_b128 v[32:35], v16 offset:49152
  ds_read_b64_tr_b16 v[40:41], v24 offset:49152
  ds_read_b64_tr_b16 v[42:43], v24 offset:50176
  ds_read_b64_tr_b16 v[44:45], v25 offset:49152
  ds_read_b64_tr_b16 v[46:47], v25 offset:50176
  ds_read_b128 v[36:39], v20 offset:49152
  v_mfma_f32_32x32x16_bf16 v[64:79], v[152:155], v[144:147], v[64:79]
  s_add_u32 s98, s3, 6
  s_and_b32 s98, s98, 7
  s_add_u32 m0, s36, 98304
  s_mul_i32 s37, s98, s39
  buffer_load_dwordx4 v10, s[44:47], s37 offen lds
  v_mfma_f32_32x32x16_bf16 v[80:95], v[144:147], v[156:159], v[80:95]
  s_add_u32 m0, s36, 99328
  s_add_u32 s37, s37, s38
  buffer_load_dwordx4 v10, s[44:47], s37 offen lds
  v_mfma_f32_32x32x16_bf16 v[96:111], v[152:155], v[148:151], v[96:111]
  v_mfma_f32_32x32x16_bf16 v[112:127], v[148:151], v[156:159], v[112:127]
  ds_read_b128 v[144:147], v17 offset:49152
  ds_read_b64_tr_b16 v[152:153], v24 offset:53248
  ds_read_b64_tr_b16 v[154:155], v24 offset:54272
  ds_read_b64_tr_b16 v[156:157], v25 offset:53248
  ds_read_b64_tr_b16 v[158:159], v25 offset:54272
  ds_read_b128 v[148:151], v21 offset:49152
  s_waitcnt lgkmcnt(6)
  v_mfma_f32_32x32x16_bf16 v[64:79], v[40:43], v[32:35], v[64:79]
  s_add_u32 m0, s36, 100352
  s_add_u32 s37, s37, s38
  buffer_load_dwordx4 v10, s[44:47], s37 offen lds
  v_mfma_f32_32x32x16_bf16 v[80:95], v[32:35], v[44:47], v[80:95]
  s_add_u32 m0, s36, 101376
  s_add_u32 s37, s37, s38
  buffer_load_dwordx4 v10, s[44:47], s37 offen lds
  v_mfma_f32_32x32x16_bf16 v[96:111], v[40:43], v[36:39], v[96:111]
  v_mfma_f32_32x32x16_bf16 v[112:127], v[36:39], v[44:47], v[112:127]
  ds_read_b128 v[32:35], v18 offset:49152
  ds_read_b64_tr_b16 v[40:41], v24 offset:57344
  ds_read_b64_tr_b16 v[42:43], v24 offset:58368
  ds_read_b64_tr_b16 v[44:45], v25 offset:57344
  ds_read_b64_tr_b16 v[46:47], v25 offset:58368
  ds_read_b128 v[36:39], v22 offset:49152
  s_waitcnt lgkmcnt(6)
  v_mfma_f32_32x32x16_bf16 v[64:79], v[152:155], v[144:147], v[64:79]
  v_mfma_f32_32x32x16_bf16 v[80:95], v[144:147], v[156:159], v[80:95]
  v_mfma_f32_32x32x16_bf16 v[96:111], v[152:155], v[148:151], v[96:111]
  v_mfma_f32_32x32x16_bf16 v[112:127], v[148:151], v[156:159], v[112:127]
  ds_read_b128 v[144:147], v19 offset:49152
  ds_read_b64_tr_b16 v[152:153], v24 offset:61440
  ds_read_b64_tr_b16 v[154:155], v24 offset:62464
  ds_read_b64_tr_b16 v[156:157], v25 offset:61440
  ds_read_b64_tr_b16 v[158:159], v25 offset:62464
  ds_read_b128 v[148:151], v23 offset:49152
  s_waitcnt lgkmcnt(6)
  v_mfma_f32_32x32x16_bf16 v[64:79], v[40:43], v[32:35], v[64:79]
  v_mfma_f32_32x32x16_bf16 v[80:95], v[32:35], v[44:47], v[80:95]
  v_mfma_f32_32x32x16_bf16 v[96:111], v[40:43], v[36:39], v[96:111]
  v_mfma_f32_32x32x16_bf16 v[112:127], v[36:39], v[44:47], v[112:127]
  s_waitcnt vmcnt(8) lgkmcnt(0)
  s_barrier
  ds_read_b128 v[32:35], v16 offset:0
  ds_read_b64_tr_b16 v[40:41], v24 offset:0
  ds_read_b64_tr_b16 v[42:43], v24 offset:1024
  ds_read_b64_tr_b16 v[44:45], v25 offset:0
  ds_read_b64_tr_b16 v[46:47], v25 offset:1024
  ds_read_b128 v[36:39], v20 offset:0
  v_mfma_f32_32x32x16_bf16 v[64:79], v[152:155], v[144:147], v[64:79]
  s_add_u32 s98, s3, 7
  s_and_b32 s98, s98, 7
  s_add_u32 m0, s36, 114688
  s_mul_i32 s37, s98, s39
  buffer_load_dwordx4 v10, s[44:47], s37 offen lds
  v_mfma_f32_32x32x16_bf16 v[80:95], v[144:147], v[156:159], v[80:95]
  s_add_u32 m0, s36, 115712
  s_add_u32 s37, s37, s38
  buffer_load_dwordx4 v10, s[44:47], s37 offen lds
  v_mfma_f32_32x32x16_bf16 v[96:111], v[152:155], v[148:151], v[96:111]
  v_mfma_f32_32x32x16_bf16 v[112:127], v[148:151], v[156:159], v[112:127]
  ds_read_b128 v[144:147], v17 offset:0
  ds_read_b64_tr_b16 v[152:153], v24 offset:4096
  ds_read_b64_tr_b16 v[154:155], v24 offset:5120
  ds_read_b64_tr_b16 v[156:157], v25 offset:4096
  ds_read_b64_tr_b16 v[158:159], v25 offset:5120
  ds_read_b128 v[148:151], v21 offset:0
  s_waitcnt lgkmcnt(6)
  v_mfma_f32_32x32x16_bf16 v[64:79], v[40:43], v[32:35], v[64:79]
  s_add_u32 m0, s36, 116736
  s_add_u32 s37, s37, s38
  buffer_load_dwordx4 v10, s[44:47], s37 offen lds
  v_mfma_f32_32x32x16_bf16 v[80:95], v[32:35], v[44:47], v[80:95]
  s_add_u32 m0, s36, 117760
  s_add_u32 s37, s37, s38
  buffer_load_dwordx4 v10, s[44:47], s37 offen lds
  v_mfma_f32_32x32x16_bf16 v[96:111], v[40:43], v[36:39], v[96:111]
  v_mfma_f32_32x32x16_bf16 v[112:127], v[36:39], v[44:47], v[112:127]
  ds_read_b128 v[32:35], v18 offset:0
  ds_read_b64_tr_b16 v[40:41], v24 offset:8192
  ds_read_b64_tr_b16 v[42:43], v24 offset:9216
  ds_read_b64_tr_b16 v[44:45], v25 offset:8192
  ds_read_b64_tr_b16 v[46:47], v25 offset:9216
  ds_read_b128 v[36:39], v22 offset:0
  s_waitcnt lgkmcnt(6)
  v_mfma_f32_32x32x16_bf16 v[64:79], v[152:155], v[144:147], v[64:79]
  v_mfma_f32_32x32x16_bf16 v[80:95], v[144:147], v[156:159], v[80:95]
  v_mfma_f32_32x32x16_bf16 v[96:111], v[152:155], v[148:151], v[96:111]
  v_mfma_f32_32x32x16_bf16 v[112:127], v[148:151], v[156:159], v[112:127]
  ds_read_b128 v[144:147], v19 offset:0
  ds_read_b64_tr_b16 v[152:153], v24 offset:12288
  ds_read_b64_tr_b16 v[154:155], v24 offset:13312
  ds_read_b64_tr_b16 v[156:157], v25 offset:12288
  ds_read_b64_tr_b16 v[158:159], v25 offset:13312
  ds_read_b128 v[148:151], v23 offset:0
  s_waitcnt lgkmcnt(6)
  v_mfma_f32_32x32x16_bf16 v[64:79], v[40:43], v[32:35], v[64:79]
  v_mfma_f32_32x32x16_bf16 v[80:95], v[32:35], v[44:47], v[80:95]
  v_mfma_f32_32x32x16_bf16 v[96:111], v[40:43], v[36:39], v[96:111]
  v_mfma_f32_32x32x16_bf16 v[112:127], v[36:39], v[44:47], v[112:127]
  s_waitcnt vmcnt(8) lgkmcnt(0)
  s_barrier
  ds_read_b128 v[32:35], v16 offset:16384
  ds_read_b64_tr_b16 v[40:41], v24 offset:16384
  ds_read_b64_tr_b16 v[42:43], v24 offset:17408
  ds_read_b64_tr_b16 v[44:45], v25 offset:16384
  ds_read_b64_tr_b16 v[46:47], v25 offset:17408
  ds_read_b128 v[36:39], v20 offset:16384
  v_mfma_f32_32x32x16_bf16 v[64:79], v[152:155], v[144:147], v[64:79]
  v_mfma_f32_32x32x16_bf16 v[80:95], v[144:147], v[156:159], v[80:95]
  v_mfma_f32_32x32x16_bf16 v[96:111], v[152:155], v[148:151], v[96:111]
  v_mfma_f32_32x32x16_bf16 v[112:127], v[148:151], v[156:159], v[112:127]
  ds_read_b128 v[144:147], v17 offset:16384
  ds_read_b64_tr_b16 v[152:153], v24 offset:20480
  ds_read_b64_tr_b16 v[154:155], v24 offset:21504
  ds_read_b64_tr_b16 v[156:157], v25 offset:20480
  ds_read_b64_tr_b16 v[158:159], v25 offset:21504
  ds_read_b128 v[148:151], v21 offset:16384
  s_waitcnt lgkmcnt(6)
  v_mfma_f32_32x32x16_bf16 v[64:79], v[40:43], v[32:35], v[64:79]
  v_mfma_f32_32x32x16_bf16 v[80:95], v[32:35], v[44:47], v[80:95]
  v_mfma_f32_32x32x16_bf16 v[96:111], v[40:43], v[36:39], v[96:111]
  v_mfma_f32_32x32x16_bf16 v[112:127], v[36:39], v[44:47], v[112:127]
  ds_read_b128 v[32:35], v18 offset:16384
  ds_read_b64_tr_b16 v[40:41], v24 offset:24576
  ds_read_b64_tr_b16 v[42:43], v24 offset:25600
  ds_read_b64_tr_b16 v[44:45], v25 offset:24576
  ds_read_b64_tr_b16 v[46:47], v25 offset:25600
  ds_read_b128 v[36:39], v22 offset:16384
  s_waitcnt lgkmcnt(6)
  v_mfma_f32_32x32x16_bf16 v[64:79], v[152:155], v[144:147], v[64:79]
  v_mfma_f32_32x32x16_bf16 v[80:95], v[144:147], v[156:159], v[80:95]
  v_mfma_f32_32x32x16_bf16 v[96:111], v[152:155], v[148:151], v[96:111]
  v_mfma_f32_32x32x16_bf16 v[112:127], v[148:151], v[156:159], v[112:127]
  ds_read_b128 v[144:147], v19 offset:16384
  ds_read_b64_tr_b16 v[152:153], v24 offset:28672
  ds_read_b64_tr_b16 v[154:155], v24 offset:29696
  ds_read_b64_tr_b16 v[156:157], v25 offset:28672
  ds_read_b64_tr_b16 v[158:159], v25 offset:29696
  ds_read_b128 v[148:151], v23 offset:16384
  s_waitcnt lgkmcnt(6)
  v_mfma_f32_32x32x16_bf16 v[64:79], v[40:43], v[32:35], v[64:79]
  v_mfma_f32_32x32x16_bf16 v[80:95], v[32:35], v[44:47], v[80:95]
  v_mfma_f32_32x32x16_bf16 v[96:111], v[40:43], v[36:39], v[96:111]
  v_mfma_f32_32x32x16_bf16 v[112:127], v[36:39], v[44:47], v[112:127]
  s_waitcnt vmcnt(4) lgkmcnt(0)
  s_barrier
  ds_read_b128 v[32:35], v16 offset:32768
  ds_read_b64_tr_b16 v[40:41], v24 offset:32768
  ds_read_b64_tr_b16 v[42:43], v24 offset:33792
  ds_read_b64_tr_b16 v[44:45], v25 offset:32768
  ds_read_b64_tr_b16 v[46:47], v25 offset:33792
  ds_read_b128 v[36:39], v20 offset:32768
  v_mfma_f32_32x32x16_bf16 v[64:79], v[152:155], v[144:147], v[64:79]
  v_mfma_f32_32x32x16_bf16 v[80:95], v[144:147], v[156:159], v[80:95]
  v_mfma_f32_32x32x16_bf16 v[96:111], v[152:155], v[148:151], v[96:111]
  v_mfma_f32_32x32x16_bf16 v[112:127], v[148:151], v[156:159], v[112:127]
  ds_read_b128 v[144:147], v17 offset:32768
  ds_read_b64_tr_b16 v[152:153], v24 offset:36864
  ds_read_b64_tr_b16 v[154:155], v24 offset:37888
  ds_read_b64_tr_b16 v[156:157], v25 offset:36864
  ds_read_b64_tr_b16 v[158:159], v25 offset:37888
  ds_read_b128 v[148:151], v21 offset:32768
  s_waitcnt lgkmcnt(6)
  v_mfma_f32_32x32x16_bf16 v[64:79], v[40:43], v[32:35], v[64:79]
  v_mfma_f32_32x32x16_bf16 v[80:95], v[32:35], v[44:47], v[80:95]
  v_mfma_f32_32x32x16_bf16 v[96:111], v[40:43], v[36:39], v[96:111]
  v_mfma_f32_32x32x16_bf16 v[112:127], v[36:39], v[44:47], v[112:127]
  ds_read_b128 v[32:35], v18 offset:32768
  ds_read_b64_tr_b16 v[40:41], v24 offset:40960
  ds_read_b64_tr_b16 v[42:43], v24 offset:41984
  ds_read_b64_tr_b16 v[44:45], v25 offset:40960
  ds_read_b64_tr_b16 v[46:47], v25 offset:41984
  ds_read_b128 v[36:39], v22 offset:32768
  s_waitcnt lgkmcnt(6)
  v_mfma_f32_32x32x16_bf16 v[64:79], v[152:155], v[144:147], v[64:79]
  v_mfma_f32_32x32x16_bf16 v[80:95], v[144:147], v[156:159], v[80:95]
  v_mfma_f32_32x32x16_bf16 v[96:111], v[152:155], v[148:151], v[96:111]
  v_mfma_f32_32x32x16_bf16 v[112:127], v[148:151], v[156:159], v[112:127]
  ds_read_b128 v[144:147], v19 offset:32768
  ds_read_b64_tr_b16 v[152:153], v24 offset:45056
  ds_read_b64_tr_b16 v[154:155], v24 offset:46080
  ds_read_b64_tr_b16 v[156:157], v25 offset:45056
  ds_read_b64_tr_b16 v[158:159], v25 offset:46080
  ds_read_b128 v[148:151], v23 offset:32768
  s_waitcnt lgkmcnt(6)
  v_mfma_f32_32x32x16_bf16 v[64:79], v[40:43], v[32:35], v[64:79]
  v_mfma_f32_32x32x16_bf16 v[80:95], v[32:35], v[44:47], v[80:95]
  v_mfma_f32_32x32x16_bf16 v[96:111], v[40:43], v[36:39], v[96:111]
  v_mfma_f32_32x32x16_bf16 v[112:127], v[36:39], v[44:47], v[112:127]
  s_waitcnt vmcnt(0) lgkmcnt(0)
  s_barrier
  ds_read_b128 v[32:35], v16 offset:49152
  ds_read_b64_tr_b16 v[40:41], v24 offset:49152
  ds_read_b64_tr_b16 v[42:43], v24 offset:50176
  ds_read_b64_tr_b16 v[44:45], v25 offset:49152
  ds_read_b64_tr_b16 v[46:47], v25 offset:50176
  ds_read_b128 v[36:39], v20 offset:49152
  buffer_load_ushort v184, v14, s[52:55], s18 offen offset:0
  buffer_load_ushort v185, v14, s[52:55], s18 offen offset:32
  buffer_load_ushort v186, v14, s[52:55], s18 offen offset:64
  buffer_load_ushort v187, v14, s[52:55], s18 offen offset:96
  buffer_load_ushort v188, v14, s[52:55], s18 offen offset:256
  buffer_load_ushort v189, v14, s[52:55], s18 offen offset:288
  buffer_load_ushort v190, v14, s[52:55], s18 offen offset:320
  buffer_load_ushort v191, v14, s[52:55], s18 offen offset:352
  buffer_load_ushort v192, v14, s[52:55], s19 offen offset:0
  buffer_load_ushort v193, v14, s[52:55], s19 offen offset:32
  buffer_load_ushort v194, v14, s[52:55], s19 offen offset:64
  buffer_load_ushort v195, v14, s[52:55], s19 offen offset:96
  buffer_load_ushort v196, v14, s[52:55], s19 offen offset:256
  buffer_load_ushort v197, v14, s[52:55], s19 offen offset:288
  buffer_load_ushort v198, v14, s[52:55], s19 offen offset:320
  buffer_load_ushort v199, v14, s[52:55], s19 offen offset:352
  v_mfma_f32_32x32x16_bf16 v[64:79], v[152:155], v[144:147], v[64:79]
  v_mfma_f32_32x32x16_bf16 v[80:95], v[144:147], v[156:159], v[80:95]
  v_mfma_f32_32x32x16_bf16 v[96:111], v[152:155], v[148:151], v[96:111]
  v_mfma_f32_32x32x16_bf16 v[112:127], v[148:151], v[156:159], v[112:127]
  ds_read_b128 v[144:147], v17 offset:49152
  ds_read_b64_tr_b16 v[152:153], v24 offset:53248
  ds_read_b64_tr_b16 v[154:155], v24 offset:54272
  ds_read_b64_tr_b16 v[156:157], v25 offset:53248
  ds_read_b64_tr_b16 v[158:159], v25 offset:54272
  ds_read_b128 v[148:151], v21 offset:49152
  s_waitcnt lgkmcnt(6)
  v_mfma_f32_32x32x16_bf16 v[64:79], v[40:43], v[32:35], v[64:79]
  v_mfma_f32_32x32x16_bf16 v[80:95], v[32:35], v[44:47], v[80:95]
  v_mfma_f32_32x32x16_bf16 v[96:111], v[40:43], v[36:39], v[96:111]
  v_mfma_f32_32x32x16_bf16 v[112:127], v[36:39], v[44:47], v[112:127]
  ds_read_b128 v[32:35], v18 offset:49152
  ds_read_b64_tr_b16 v[40:41], v24 offset:57344
  ds_read_b64_tr_b16 v[42:43], v24 offset:58368
  ds_read_b64_tr_b16 v[44:45], v25 offset:57344
  ds_read_b64_tr_b16 v[46:47], v25 offset:58368
  ds_read_b128 v[36:39], v22 offset:49152
  s_waitcnt lgkmcnt(6)
  v_mfma_f32_32x32x16_bf16 v[64:79], v[152:155], v[144:147], v[64:79]
  v_mfma_f32_32x32x16_bf16 v[80:95], v[144:147], v[156:159], v[80:95]
  v_mfma_f32_32x32x16_bf16 v[96:111], v[152:155], v[148:151], v[96:111]
  v_mfma_f32_32x32x16_bf16 v[112:127], v[148:151], v[156:159], v[112:127]
  ds_read_b128 v[144:147], v19 offset:49152
  ds_read_b64_tr_b16 v[152:153], v24 offset:61440
  ds_read_b64_tr_b16 v[154:155], v24 offset:62464
  ds_read_b64_tr_b16 v[156:157], v25 offset:61440
  ds_read_b64_tr_b16 v[158:159], v25 offset:62464
  ds_read_b128 v[148:151], v23 offset:49152
  s_waitcnt lgkmcnt(6)
  v_mfma_f32_32x32x16_bf16 v[64:79], v[40:43], v[32:35], v[64:79]
  v_mfma_f32_32x32x16_bf16 v[80:95], v[32:35], v[44:47], v[80:95]
  v_mfma_f32_32x32x16_bf16 v[96:111], v[40:43], v[36:39], v[96:111]
  v_mfma_f32_32x32x16_bf16 v[112:127], v[36:39], v[44:47], v[112:127]
  s_waitcnt vmcnt(0) lgkmcnt(0)
  s_barrier
  v_mfma_f32_32x32x16_bf16 v[64:79], v[152:155], v[144:147], v[64:79]
  v_mfma_f32_32x32x16_bf16 v[80:95], v[144:147], v[156:159], v[80:95]
  v_mfma_f32_32x32x16_bf16 v[96:111], v[152:155], v[148:151], v[96:111]
  v_mfma_f32_32x32x16_bf16 v[112:127], v[148:151], v[156:159], v[112:127]
  v_lshl_or_b32 v168, v185, 16, v184
  v_lshl_or_b32 v169, v187, 16, v186
  v_lshl_or_b32 v170, v189, 16, v188
  v_lshl_or_b32 v171, v191, 16, v190
  v_lshl_or_b32 v172, v193, 16, v192
  v_lshl_or_b32 v173, v195, 16, v194
  v_lshl_or_b32 v174, v197, 16, v196
  v_lshl_or_b32 v175, v199, 16, v198
  v_xor_b32 v168, v168, v15
  v_xor_b32 v169, v169, v15
  v_xor_b32 v170, v170, v15
  v_xor_b32 v171, v171, v15
  v_xor_b32 v172, v172, v15
  v_xor_b32 v173, v173, v15
  v_xor_b32 v174, v174, v15
  v_xor_b32 v175, v175, v15
  v_cvt_pk_bf16_f32 v64, v64, v65
  v_cvt_pk_bf16_f32 v65, v66, v67
  v_cvt_pk_bf16_f32 v66, v68, v69
  v_cvt_pk_bf16_f32 v67, v70, v71
  v_cvt_pk_bf16_f32 v68, v72, v73
  v_cvt_pk_bf16_f32 v69, v74, v75
  v_cvt_pk_bf16_f32 v70, v76, v77
  v_cvt_pk_bf16_f32 v71, v78, v79
  v_cvt_pk_bf16_f32 v96, v96, v97
  v_cvt_pk_bf16_f32 v97, v98, v99
  v_cvt_pk_bf16_f32 v98, v100, v101
  v_cvt_pk_bf16_f32 v99, v102, v103
  v_cvt_pk_bf16_f32 v100, v104, v105
  v_cvt_pk_bf16_f32 v101, v106, v107
  v_cvt_pk_bf16_f32 v102, v108, v109
  v_cvt_pk_bf16_f32 v103, v110, v111
  s_nop 1
  v_mfma_f32_32x32x16_bf16 v[184:199], v[168:171], v[64:67], 0
  v_mfma_f32_32x32x16_bf16 v[200:215], v[172:175], v[68:71], 0
  v_mfma_f32_32x32x16_bf16 v[216:231], v[168:171], v[96:99], 0
  v_mfma_f32_32x32x16_bf16 v[232:247], v[172:175], v[100:103], 0
  v_mov_b32 v2, 0x3f803f80
  v_cvt_pk_bf16_f32 v80, v80, v81
  v_cvt_pk_bf16_f32 v81, v82, v83
  v_cvt_pk_bf16_f32 v82, v84, v85
  v_cvt_pk_bf16_f32 v83, v86, v87
  v_cvt_pk_bf16_f32 v84, v88, v89
  v_cvt_pk_bf16_f32 v85, v90, v91
  v_cvt_pk_bf16_f32 v86, v92, v93
  v_cvt_pk_bf16_f32 v87, v94, v95
  v_cndmask_b32 v88, v2, v80, s[70:71]
  v_cndmask_b32 v80, v80, v2, s[70:71]
  v_cndmask_b32 v89, v2, v81, s[70:71]
  v_cndmask_b32 v81, v81, v2, s[70:71]
  v_cndmask_b32 v90, v2, v82, s[70:71]
  v_cndmask_b32 v82, v82, v2, s[70:71]
  v_cndmask_b32 v91, v2, v83, s[70:71]
  v_cndmask_b32 v83, v83, v2, s[70:71]
  v_cndmask_b32 v92, v2, v84, s[70:71]
  v_cndmask_b32 v84, v84, v2, s[70:71]
  v_cndmask_b32 v93, v2, v85, s[70:71]
  v_cndmask_b32 v85, v85, v2, s[70:71]
  v_cndmask_b32 v94, v2, v86, s[70:71]
  v_cndmask_b32 v86, v86, v2, s[70:71]
  v_cndmask_b32 v95, v2, v87, s[70:71]
  v_cndmask_b32 v87, v87, v2, s[70:71]
  v_cvt_pk_bf16_f32 v112, v112, v113
  v_cvt_pk_bf16_f32 v113, v114, v115
  v_cvt_pk_bf16_f32 v114, v116, v117
  v_cvt_pk_bf16_f32 v115, v118, v119
  v_cvt_pk_bf16_f32 v116, v120, v121
  v_cvt_pk_bf16_f32 v117, v122, v123
  v_cvt_pk_bf16_f32 v118, v124, v125
  v_cvt_pk_bf16_f32 v119, v126, v127
  v_cndmask_b32 v120, v2, v112, s[70:71]
  v_cndmask_b32 v112, v112, v2, s[70:71]
  v_cndmask_b32 v121, v2, v113, s[70:71]
  v_cndmask_b32 v113, v113, v2, s[70:71]
  v_cndmask_b32 v122, v2, v114, s[70:71]
  v_cndmask_b32 v114, v114, v2, s[70:71]
  v_cndmask_b32 v123, v2, v115, s[70:71]
  v_cndmask_b32 v115, v115, v2, s[70:71]
  v_cndmask_b32 v124, v2, v116, s[70:71]
  v_cndmask_b32 v116, v116, v2, s[70:71]
  v_cndmask_b32 v125, v2, v117, s[70:71]
  v_cndmask_b32 v117, v117, v2, s[70:71]
  v_cndmask_b32 v126, v2, v118, s[70:71]
  v_cndmask_b32 v118, v118, v2, s[70:71]
  v_cndmask_b32 v127, v2, v119, s[70:71]
  v_cndmask_b32 v119, v119, v2, s[70:71]
  v_max3_f32 v32, v184, v185, v186
  v_max3_f32 v34, v187, v188, v189
  v_max3_f32 v33, v192, v193, v194
  v_max3_f32 v35, v195, v196, v197
  v_max3_f32 v32, v32, v190, v191
  v_max3_f32 v33, v33, v198, v199
  v_max_f32 v32, v32, v34
  v_max_f32 v33, v33, v35
  v_max3_f32 v36, v200, v201, v202
  v_max3_f32 v38, v203, v204, v205
  v_max3_f32 v37, v208, v209, v210
  v_max3_f32 v39, v211, v212, v213
  v_max3_f32 v36, v36, v206, v207
  v_max3_f32 v37, v37, v214, v215
  v_max_f32 v36, v36, v38
  v_max_f32 v37, v37, v39
  v_max3_f32 v40, v216, v217, v218
  v_max3_f32 v42, v219, v220, v221
  v_max3_f32 v41, v224, v225, v226
  v_max3_f32 v43, v227, v228, v229
  v_max3_f32 v40, v40, v222, v223
  v_max3_f32 v41, v41, v230, v231
  v_max_f32 v40, v40, v42
  v_max_f32 v41, v41, v43
  v_max3_f32 v44, v232, v233, v234
  v_max3_f32 v46, v235, v236, v237
  v_max3_f32 v45, v240, v241, v242
  v_max3_f32 v47, v243, v244, v245
  v_max3_f32 v44, v44, v238, v239
  v_max3_f32 v45, v45, v246, v247
  v_max_f32 v44, v44, v46
  v_max_f32 v45, v45, v47
  s_nop 1
  v_permlane32_swap_b32 v32, v33
  v_permlane32_swap_b32 v36, v37
  v_permlane32_swap_b32 v40, v41
  v_permlane32_swap_b32 v44, v45
  s_nop 1
  v_max_f32 v32, v32, v33
  v_max_f32 v36, v36, v37
  v_max_f32 v40, v40, v41
  v_max_f32 v44, v44, v45
  v_mul_f32 v32, 0xbfb8aa3b, v32
  v_mul_f32 v36, 0xbfb8aa3b, v36
  v_mul_f32 v40, 0xbfb8aa3b, v40
  v_mul_f32 v44, 0xbfb8aa3b, v44
  s_nop 0
  v_mov_b32 v34, v32
  v_mov_b32 v38, v36
  v_mov_b32 v42, v40
  v_mov_b32 v46, v44
  s_nop 1
  v_permlane32_swap_b32 v32, v34
  v_permlane32_swap_b32 v36, v38
  v_permlane32_swap_b32 v40, v42
  v_permlane32_swap_b32 v44, v46
  s_nop 1
  v_pk_fma_f32 v[184:185], v[184:185], s[72:73], v[32:33] op_sel_hi:[1,1,0]
  v_pk_fma_f32 v[186:187], v[186:187], s[72:73], v[32:33] op_sel_hi:[1,1,0]
  v_pk_fma_f32 v[188:189], v[188:189], s[72:73], v[32:33] op_sel_hi:[1,1,0]
  v_pk_fma_f32 v[190:191], v[190:191], s[72:73], v[32:33] op_sel_hi:[1,1,0]
  v_pk_fma_f32 v[192:193], v[192:193], s[72:73], v[34:35] op_sel_hi:[1,1,0]
  v_pk_fma_f32 v[194:195], v[194:195], s[72:73], v[34:35] op_sel_hi:[1,1,0]
  v_pk_fma_f32 v[196:197], v[196:197], s[72:73], v[34:35] op_sel_hi:[1,1,0]
  v_pk_fma_f32 v[198:199], v[198:199], s[72:73], v[34:35] op_sel_hi:[1,1,0]
  v_exp_f32 v184, v184
  v_exp_f32 v185, v185
  v_exp_f32 v186, v186
  v_exp_f32 v187, v187
  v_exp_f32 v188, v188
  v_exp_f32 v189, v189
  v_exp_f32 v190, v190
  v_exp_f32 v191, v191
  v_exp_f32 v192, v192
  v_exp_f32 v193, v193
  v_exp_f32 v194, v194
  v_exp_f32 v195, v195
  v_exp_f32 v196, v196
  v_exp_f32 v197, v197
  v_exp_f32 v198, v198
  v_exp_f32 v199, v199
  v_pk_fma_f32 v[200:201], v[200:201], s[72:73], v[36:37] op_sel_hi:[1,1,0]
  v_pk_fma_f32 v[202:203], v[202:203], s[72:73], v[36:37] op_sel_hi:[1,1,0]
  v_pk_fma_f32 v[204:205], v[204:205], s[72:73], v[36:37] op_sel_hi:[1,1,0]
  v_pk_fma_f32 v[206:207], v[206:207], s[72:73], v[36:37] op_sel_hi:[1,1,0]
  v_pk_fma_f32 v[208:209], v[208:209], s[72:73], v[38:39] op_sel_hi:[1,1,0]
  v_pk_fma_f32 v[210:211], v[210:211], s[72:73], v[38:39] op_sel_hi:[1,1,0]
  v_pk_fma_f32 v[212:213], v[212:213], s[72:73], v[38:39] op_sel_hi:[1,1,0]
  v_pk_fma_f32 v[214:215], v[214:215], s[72:73], v[38:39] op_sel_hi:[1,1,0]
  v_exp_f32 v200, v200
  v_exp_f32 v201, v201
  v_exp_f32 v202, v202
  v_exp_f32 v203, v203
  v_exp_f32 v204, v204
  v_exp_f32 v205, v205
  v_exp_f32 v206, v206
  v_exp_f32 v207, v207
  v_exp_f32 v208, v208
  v_exp_f32 v209, v209
  v_exp_f32 v210, v210
  v_exp_f32 v211, v211
  v_exp_f32 v212, v212
  v_exp_f32 v213, v213
  v_exp_f32 v214, v214
  v_exp_f32 v215, v215
  v_pk_fma_f32 v[216:217], v[216:217], s[72:73], v[40:41] op_sel_hi:[1,1,0]
  v_pk_fma_f32 v[218:219], v[218:219], s[72:73], v[40:41] op_sel_hi:[1,1,0]
  v_pk_fma_f32 v[220:221], v[220:221], s[72:73], v[40:41] op_sel_hi:[1,1,0]
  v_pk_fma_f32 v[222:223], v[222:223], s[72:73], v[40:41] op_sel_hi:[1,1,0]
  v_pk_fma_f32 v[224:225], v[224:225], s[72:73], v[42:43] op_sel_hi:[1,1,0]
  v_pk_fma_f32 v[226:227], v[226:227], s[72:73], v[42:43] op_sel_hi:[1,1,0]
  v_pk_fma_f32 v[228:229], v[228:229], s[72:73], v[42:43] op_sel_hi:[1,1,0]
  v_pk_fma_f32 v[230:231], v[230:231], s[72:73], v[42:43] op_sel_hi:[1,1,0]
  v_exp_f32 v216, v216
  v_exp_f32 v217, v217
  v_exp_f32 v218, v218
  v_exp_f32 v219, v219
  v_exp_f32 v220, v220
  v_exp_f32 v221, v221
  v_exp_f32 v222, v222
  v_exp_f32 v223, v223
  v_exp_f32 v224, v224
  v_exp_f32 v225, v225
  v_exp_f32 v226, v226
  v_exp_f32 v227, v227
  v_exp_f32 v228, v228
  v_exp_f32 v229, v229
  v_exp_f32 v230, v230
  v_exp_f32 v231, v231
  v_pk_fma_f32 v[232:233], v[232:233], s[72:73], v[44:45] op_sel_hi:[1,1,0]
  v_pk_fma_f32 v[234:235], v[234:235], s[72:73], v[44:45] op_sel_hi:[1,1,0]
  v_pk_fma_f32 v[236:237], v[236:237], s[72:73], v[44:45] op_sel_hi:[1,1,0]
  v_pk_fma_f32 v[238:239], v[238:239], s[72:73], v[44:45] op_sel_hi:[1,1,0]
  v_pk_fma_f32 v[240:241], v[240:241], s[72:73], v[46:47] op_sel_hi:[1,1,0]
  v_pk_fma_f32 v[242:243], v[242:243], s[72:73], v[46:47] op_sel_hi:[1,1,0]
  v_pk_fma_f32 v[244:245], v[244:245], s[72:73], v[46:47] op_sel_hi:[1,1,0]
  v_pk_fma_f32 v[246:247], v[246:247], s[72:73], v[46:47] op_sel_hi:[1,1,0]
  v_exp_f32 v232, v232
  v_exp_f32 v233, v233
  v_exp_f32 v234, v234
  v_exp_f32 v235, v235
  v_exp_f32 v236, v236
  v_exp_f32 v237, v237
  v_exp_f32 v238, v238
  v_exp_f32 v239, v239
  v_exp_f32 v240, v240
  v_exp_f32 v241, v241
  v_exp_f32 v242, v242
  v_exp_f32 v243, v243
  v_exp_f32 v244, v244
  v_exp_f32 v245, v245
  v_exp_f32 v246, v246
  v_exp_f32 v247, v247
  v_pk_add_f32 v[32:33], v[184:185], v[186:187]
  v_pk_add_f32 v[34:35], v[192:193], v[194:195]
  v_pk_add_f32 v[32:33], v[32:33], v[188:189]
  v_pk_add_f32 v[34:35], v[34:35], v[196:197]
  v_pk_add_f32 v[32:33], v[32:33], v[190:191]
  v_pk_add_f32 v[34:35], v[34:35], v[198:199]
  v_add_f32 v32, v32, v33
  v_add_f32 v33, v34, v35
  v_pk_add_f32 v[36:37], v[200:201], v[202:203]
  v_pk_add_f32 v[38:39], v[208:209], v[210:211]
  v_pk_add_f32 v[36:37], v[36:37], v[204:205]
  v_pk_add_f32 v[38:39], v[38:39], v[212:213]
  v_pk_add_f32 v[36:37], v[36:37], v[206:207]
  v_pk_add_f32 v[38:39], v[38:39], v[214:215]
  v_add_f32 v36, v36, v37
  v_add_f32 v37, v38, v39
  v_pk_add_f32 v[40:41], v[216:217], v[218:219]
  v_pk_add_f32 v[42:43], v[224:225], v[226:227]
  v_pk_add_f32 v[40:41], v[40:41], v[220:221]
  v_pk_add_f32 v[42:43], v[42:43], v[228:229]
  v_pk_add_f32 v[40:41], v[40:41], v[222:223]
  v_pk_add_f32 v[42:43], v[42:43], v[230:231]
  v_add_f32 v40, v40, v41
  v_add_f32 v41, v42, v43
  v_pk_add_f32 v[44:45], v[232:233], v[234:235]
  v_pk_add_f32 v[46:47], v[240:241], v[242:243]
  v_pk_add_f32 v[44:45], v[44:45], v[236:237]
  v_pk_add_f32 v[46:47], v[46:47], v[244:245]
  v_pk_add_f32 v[44:45], v[44:45], v[238:239]
  v_pk_add_f32 v[46:47], v[46:47], v[246:247]
  v_add_f32 v44, v44, v45
  v_add_f32 v45, v46, v47
  s_nop 1
  v_permlane32_swap_b32 v32, v33
  v_permlane32_swap_b32 v36, v37
  v_permlane32_swap_b32 v40, v41
  v_permlane32_swap_b32 v44, v45
  s_nop 1
  v_add_f32 v32, v32, v33
  v_add_f32 v36, v36, v37
  v_add_f32 v40, v40, v41
  v_add_f32 v44, v44, v45
  v_rcp_f32 v32, v32
  v_rcp_f32 v36, v36
  v_rcp_f32 v40, v40
  v_rcp_f32 v44, v44
  s_nop 0
  v_mov_b32 v34, v32
  v_mov_b32 v38, v36
  v_mov_b32 v42, v40
  v_mov_b32 v46, v44
  s_nop 1
  v_permlane32_swap_b32 v32, v34
  v_permlane32_swap_b32 v36, v38
  v_permlane32_swap_b32 v40, v42
  v_permlane32_swap_b32 v44, v46
  s_nop 1
  v_pk_mul_f32 v[184:185], v[184:185], v[32:33] op_sel_hi:[1,0]
  v_pk_mul_f32 v[186:187], v[186:187], v[32:33] op_sel_hi:[1,0]
  v_pk_mul_f32 v[188:189], v[188:189], v[32:33] op_sel_hi:[1,0]
  v_pk_mul_f32 v[190:191], v[190:191], v[32:33] op_sel_hi:[1,0]
  v_pk_mul_f32 v[192:193], v[192:193], v[34:35] op_sel_hi:[1,0]
  v_pk_mul_f32 v[194:195], v[194:195], v[34:35] op_sel_hi:[1,0]
  v_pk_mul_f32 v[196:197], v[196:197], v[34:35] op_sel_hi:[1,0]
  v_pk_mul_f32 v[198:199], v[198:199], v[34:35] op_sel_hi:[1,0]
  v_pk_mul_f32 v[200:201], v[200:201], v[36:37] op_sel_hi:[1,0]
  v_pk_mul_f32 v[202:203], v[202:203], v[36:37] op_sel_hi:[1,0]
  v_pk_mul_f32 v[204:205], v[204:205], v[36:37] op_sel_hi:[1,0]
  v_pk_mul_f32 v[206:207], v[206:207], v[36:37] op_sel_hi:[1,0]
  v_pk_mul_f32 v[208:209], v[208:209], v[38:39] op_sel_hi:[1,0]
  v_pk_mul_f32 v[210:211], v[210:211], v[38:39] op_sel_hi:[1,0]
  v_pk_mul_f32 v[212:213], v[212:213], v[38:39] op_sel_hi:[1,0]
  v_pk_mul_f32 v[214:215], v[214:215], v[38:39] op_sel_hi:[1,0]
  v_pk_mul_f32 v[216:217], v[216:217], v[40:41] op_sel_hi:[1,0]
  v_pk_mul_f32 v[218:219], v[218:219], v[40:41] op_sel_hi:[1,0]
  v_pk_mul_f32 v[220:221], v[220:221], v[40:41] op_sel_hi:[1,0]
  v_pk_mul_f32 v[222:223], v[222:223], v[40:41] op_sel_hi:[1,0]
  v_pk_mul_f32 v[224:225], v[224:225], v[42:43] op_sel_hi:[1,0]
  v_pk_mul_f32 v[226:227], v[226:227], v[42:43] op_sel_hi:[1,0]
  v_pk_mul_f32 v[228:229], v[228:229], v[42:43] op_sel_hi:[1,0]
  v_pk_mul_f32 v[230:231], v[230:231], v[42:43] op_sel_hi:[1,0]
  v_pk_mul_f32 v[232:233], v[232:233], v[44:45] op_sel_hi:[1,0]
  v_pk_mul_f32 v[234:235], v[234:235], v[44:45] op_sel_hi:[1,0]
  v_pk_mul_f32 v[236:237], v[236:237], v[44:45] op_sel_hi:[1,0]
  v_pk_mul_f32 v[238:239], v[238:239], v[44:45] op_sel_hi:[1,0]
  v_pk_mul_f32 v[240:241], v[240:241], v[46:47] op_sel_hi:[1,0]
  v_pk_mul_f32 v[242:243], v[242:243], v[46:47] op_sel_hi:[1,0]
  v_pk_mul_f32 v[244:245], v[244:245], v[46:47] op_sel_hi:[1,0]
  v_pk_mul_f32 v[246:247], v[246:247], v[46:47] op_sel_hi:[1,0]
  v_cvt_pk_bf16_f32 v184, v184, v185
  v_cvt_pk_bf16_f32 v185, v186, v187
  v_cvt_pk_bf16_f32 v186, v188, v189
  v_cvt_pk_bf16_f32 v187, v190, v191
  v_cvt_pk_bf16_f32 v188, v192, v193
  v_cvt_pk_bf16_f32 v189, v194, v195
  v_cvt_pk_bf16_f32 v190, v196, v197
  v_cvt_pk_bf16_f32 v191, v198, v199
  s_nop 1
  v_mfma_f32_32x32x16_bf16 v[32:47], v[184:187], v[176:179], 0
  v_mfma_f32_32x32x16_bf16 v[32:47], v[188:191], v[180:183], v[32:47]
  v_cvt_pk_bf16_f32 v200, v200, v201
  v_cvt_pk_bf16_f32 v201, v202, v203
  v_cvt_pk_bf16_f32 v202, v204, v205
  v_cvt_pk_bf16_f32 v203, v206, v207
  v_cvt_pk_bf16_f32 v204, v208, v209
  v_cvt_pk_bf16_f32 v205, v210, v211
  v_cvt_pk_bf16_f32 v206, v212, v213
  v_cvt_pk_bf16_f32 v207, v214, v215
  s_nop 1
  v_mfma_f32_32x32x16_bf16 v[48:63], v[200:203], v[176:179], 0
  v_mfma_f32_32x32x16_bf16 v[48:63], v[204:207], v[180:183], v[48:63]
  v_cvt_pk_bf16_f32 v216, v216, v217
  v_cvt_pk_bf16_f32 v217, v218, v219
  v_cvt_pk_bf16_f32 v218, v220, v221
  v_cvt_pk_bf16_f32 v219, v222, v223
  v_cvt_pk_bf16_f32 v220, v224, v225
  v_cvt_pk_bf16_f32 v221, v226, v227
  v_cvt_pk_bf16_f32 v222, v228, v229
  v_cvt_pk_bf16_f32 v223, v230, v231
  s_nop 1
  v_mfma_f32_32x32x16_bf16 v[144:159], v[216:219], v[176:179], 0
  v_mfma_f32_32x32x16_bf16 v[144:159], v[220:223], v[180:183], v[144:159]
  v_cvt_pk_bf16_f32 v232, v232, v233
  v_cvt_pk_bf16_f32 v233, v234, v235
  v_cvt_pk_bf16_f32 v234, v236, v237
  v_cvt_pk_bf16_f32 v235, v238, v239
  v_cvt_pk_bf16_f32 v236, v240, v241
  v_cvt_pk_bf16_f32 v237, v242, v243
  v_cvt_pk_bf16_f32 v238, v244, v245
  v_cvt_pk_bf16_f32 v239, v246, v247
  s_nop 1
  v_mfma_f32_32x32x16_bf16 v[64:79], v[232:235], v[176:179], 0
  v_mfma_f32_32x32x16_bf16 v[64:79], v[236:239], v[180:183], v[64:79]
  s_nop 5
  v_cvt_pk_bf16_f32 v32, v32, v33
  v_cvt_pk_bf16_f32 v33, v34, v35
  v_cvt_pk_bf16_f32 v34, v36, v37
  v_cvt_pk_bf16_f32 v35, v38, v39
  v_cvt_pk_bf16_f32 v36, v40, v41
  v_cvt_pk_bf16_f32 v37, v42, v43
  v_cvt_pk_bf16_f32 v38, v44, v45
  v_cvt_pk_bf16_f32 v39, v46, v47
  s_nop 1
  v_mfma_f32_32x32x16_bf16 v[184:199], v[32:35], v[80:83], 0
  v_mfma_f32_32x32x16_bf16 v[184:199], v[36:39], v[84:87], v[184:199]
  v_cvt_pk_bf16_f32 v48, v48, v49
  v_cvt_pk_bf16_f32 v49, v50, v51
  v_cvt_pk_bf16_f32 v50, v52, v53
  v_cvt_pk_bf16_f32 v51, v54, v55
  v_cvt_pk_bf16_f32 v52, v56, v57
  v_cvt_pk_bf16_f32 v53, v58, v59
  v_cvt_pk_bf16_f32 v54, v60, v61
  v_cvt_pk_bf16_f32 v55, v62, v63
  s_nop 1
  v_mfma_f32_32x32x16_bf16 v[200:215], v[48:51], v[88:91], 0
  v_mfma_f32_32x32x16_bf16 v[200:215], v[52:55], v[92:95], v[200:215]
  v_cvt_pk_bf16_f32 v144, v144, v145
  v_cvt_pk_bf16_f32 v145, v146, v147
  v_cvt_pk_bf16_f32 v146, v148, v149
  v_cvt_pk_bf16_f32 v147, v150, v151
  v_cvt_pk_bf16_f32 v148, v152, v153
  v_cvt_pk_bf16_f32 v149, v154, v155
  v_cvt_pk_bf16_f32 v150, v156, v157
  v_cvt_pk_bf16_f32 v151, v158, v159
  s_nop 1
  v_mfma_f32_32x32x16_bf16 v[184:199], v[144:147], v[112:115], v[184:199]
  v_mfma_f32_32x32x16_bf16 v[184:199], v[148:151], v[116:119], v[184:199]
  s_nop 1
  v_cvt_pk_bf16_f32 v64, v64, v65
  v_cvt_pk_bf16_f32 v65, v66, v67
  v_cvt_pk_bf16_f32 v66, v68, v69
  v_cvt_pk_bf16_f32 v67, v70, v71
  v_cvt_pk_bf16_f32 v68, v72, v73
  v_cvt_pk_bf16_f32 v69, v74, v75
  v_cvt_pk_bf16_f32 v70, v76, v77
  v_cvt_pk_bf16_f32 v71, v78, v79
  s_nop 1
  v_mfma_f32_32x32x16_bf16 v[200:215], v[64:67], v[120:123], v[200:215]
  v_mfma_f32_32x32x16_bf16 v[200:215], v[68:71], v[124:127], v[200:215]
  s_lshl_b32 s34, s21, 12
  v_add_u32 v3, s34, v13
  v_xor_b32 v4, 8192, v3
  v_add_u32 v3, 135168, v3
  v_add_u32 v4, 135168, v4
  s_add_u32 s65, s65, s26
  s_lshl_b32 s65, s65, 4
  s_add_u32 s65, s65, s24
  s_lshl_b32 s65, s65, 12
  s_add_u32 s65, s65, 5242880
  s_lshl_b32 s34, s26, 4
  v_xor_b32 v5, s34, v0
  v_lshlrev_b32 v5, 3, v5
  s_nop 4
  s_cmp_eq_u32 s26, 0
  s_cbranch_scc1 K1_X0
  ds_write_b128 v3, v[184:187] offset:0
  ds_write_b128 v3, v[188:191] offset:1024
  ds_write_b128 v3, v[192:195] offset:2048
  ds_write_b128 v3, v[196:199] offset:3072
  s_waitcnt lgkmcnt(0)
  s_barrier
  ds_read_b128 v[32:35], v4 offset:0
  ds_read_b128 v[36:39], v4 offset:1024
  ds_read_b128 v[40:43], v4 offset:2048
  ds_read_b128 v[44:47], v4 offset:3072
  s_waitcnt lgkmcnt(3)
  v_pk_add_f32 v[200:201], v[200:201], v[32:33]
  buffer_store_dwordx2 v[200:201], v5, s[56:59], s65 offen offset:0 sc1
  v_pk_add_f32 v[202:203], v[202:203], v[34:35]
  buffer_store_dwordx2 v[202:203], v5, s[56:59], s65 offen offset:512 sc1
  s_waitcnt lgkmcnt(2)
  v_pk_add_f32 v[204:205], v[204:205], v[36:37]
  buffer_store_dwordx2 v[204:205], v5, s[56:59], s65 offen offset:1024 sc1
  v_pk_add_f32 v[206:207], v[206:207], v[38:39]
  buffer_store_dwordx2 v[206:207], v5, s[56:59], s65 offen offset:1536 sc1
  s_waitcnt lgkmcnt(1)
  v_pk_add_f32 v[208:209], v[208:209], v[40:41]
  buffer_store_dwordx2 v[208:209], v5, s[56:59], s65 offen offset:2048 sc1
  v_pk_add_f32 v[210:211], v[210:211], v[42:43]
  buffer_store_dwordx2 v[210:211], v5, s[56:59], s65 offen offset:2560 sc1
  s_waitcnt lgkmcnt(0)
  v_pk_add_f32 v[212:213], v[212:213], v[44:45]
  buffer_store_dwordx2 v[212:213], v5, s[56:59], s65 offen offset:3072 sc1
  v_pk_add_f32 v[214:215], v[214:215], v[46:47]
  buffer_store_dwordx2 v[214:215], v5, s[56:59], s65 offen offset:3584 sc1
  s_branch K1_SIG
K1_X0:
  ds_write_b128 v3, v[200:203] offset:0
  ds_write_b128 v3, v[204:207] offset:1024
  ds_write_b128 v3, v[208:211] offset:2048
  ds_write_b128 v3, v[212:215] offset:3072
  s_waitcnt lgkmcnt(0)
  s_barrier
  ds_read_b128 v[32:35], v4 offset:0
  ds_read_b128 v[36:39], v4 offset:1024
  ds_read_b128 v[40:43], v4 offset:2048
  ds_read_b128 v[44:47], v4 offset:3072
  s_waitcnt lgkmcnt(3)
  v_pk_add_f32 v[184:185], v[184:185], v[32:33]
  buffer_store_dwordx2 v[184:185], v5, s[56:59], s65 offen offset:0 sc1
  v_pk_add_f32 v[186:187], v[186:187], v[34:35]
  buffer_store_dwordx2 v[186:187], v5, s[56:59], s65 offen offset:512 sc1
  s_waitcnt lgkmcnt(2)
  v_pk_add_f32 v[188:189], v[188:189], v[36:37]
  buffer_store_dwordx2 v[188:189], v5, s[56:59], s65 offen offset:1024 sc1
  v_pk_add_f32 v[190:191], v[190:191], v[38:39]
  buffer_store_dwordx2 v[190:191], v5, s[56:59], s65 offen offset:1536 sc1
  s_waitcnt lgkmcnt(1)
  v_pk_add_f32 v[192:193], v[192:193], v[40:41]
  buffer_store_dwordx2 v[192:193], v5, s[56:59], s65 offen offset:2048 sc1
  v_pk_add_f32 v[194:195], v[194:195], v[42:43]
  buffer_store_dwordx2 v[194:195], v5, s[56:59], s65 offen offset:2560 sc1
  s_waitcnt lgkmcnt(0)
  v_pk_add_f32 v[196:197], v[196:197], v[44:45]
  buffer_store_dwordx2 v[196:197], v5, s[56:59], s65 offen offset:3072 sc1
  v_pk_add_f32 v[198:199], v[198:199], v[46:47]
  buffer_store_dwordx2 v[198:199], v5, s[56:59], s65 offen offset:3584 sc1
K1_SIG:
  s_waitcnt vmcnt(0)
  s_barrier
  s_cmp_lg_u32 s67, 0
  s_cbranch_scc1 K2_START
  v_mov_b32 v3, 163832
  ds_read_b32 v2, v3
  s_lshl_b32 s34, s20, 5
  s_add_u32 s34, s34, s22
  s_lshl_b32 s34, s34, 2
  s_add_u32 s34, s34, 7405568
  v_lshlrev_b32 v3, 10, v0
  s_waitcnt lgkmcnt(0)
  buffer_store_dword v2, v3, s[56:59], s34 offen sc1
  s_branch K2_START
K1_LD:
  s_memrealtime s[34:35]
  s_add_u32 s98, s3, 0
  s_and_b32 s98, s98, 7
  s_lshl_b32 s62, s98, 7
  buffer_load_dwordx4 v[64:67], v11, s[40:43], s62 offen
  s_add_u32 s62, s62, 8192
  buffer_load_dwordx4 v[68:71], v12, s[40:43], s62 offen
  s_add_u32 s62, s62, 8192
  buffer_load_dwordx4 v[72:75], v11, s[40:43], s62 offen
  s_add_u32 s62, s62, 8192
  buffer_load_dwordx4 v[76:79], v12, s[40:43], s62 offen
  s_add_u32 s62, s62, 8192
  s_add_u32 s98, s3, 1
  s_and_b32 s98, s98, 7
  s_lshl_b32 s62, s98, 7
  buffer_load_dwordx4 v[80:83], v11, s[40:43], s62 offen
  s_add_u32 s62, s62, 8192
  buffer_load_dwordx4 v[84:87], v12, s[40:43], s62 offen
  s_add_u32 s62, s62, 8192
  buffer_load_dwordx4 v[88:91], v11, s[40:43], s62 offen
  s_add_u32 s62, s62, 8192
  buffer_load_dwordx4 v[92:95], v12, s[40:43], s62 offen
  s_add_u32 s62, s62, 8192
  s_add_u32 s98, s3, 2
  s_and_b32 s98, s98, 7
  s_lshl_b32 s62, s98, 7
  buffer_load_dwordx4 v[96:99], v11, s[40:43], s62 offen
  s_add_u32 s62, s62, 8192
  buffer_load_dwordx4 v[100:103], v12, s[40:43], s62 offen
  s_add_u32 s62, s62, 8192
  buffer_load_dwordx4 v[104:107], v11, s[40:43], s62 offen
  s_add_u32 s62, s62, 8192
  buffer_load_dwordx4 v[108:111], v12, s[40:43], s62 offen
  s_add_u32 s62, s62, 8192
  s_add_u32 s98, s3, 3
  s_and_b32 s98, s98, 7
  s_lshl_b32 s62, s98, 7
  buffer_load_dwordx4 v[112:115], v11, s[40:43], s62 offen
  s_add_u32 s62, s62, 8192
  buffer_load_dwordx4 v[116:119], v12, s[40:43], s62 offen
  s_add_u32 s62, s62, 8192
  buffer_load_dwordx4 v[120:123], v11, s[40:43], s62 offen
  s_add_u32 s62, s62, 8192
  buffer_load_dwordx4 v[124:127], v12, s[40:43], s62 offen
  s_add_u32 s62, s62, 8192
  s_lshl_b32 s36, s21, 12
  v_add_u32 v4, s36, v13
  v_mov_b32 v5, 163832
  v_mov_b32 v7, 0
  ds_write_b32 v5, v7 offset:4
  s_waitcnt lgkmcnt(0)
  s_or_b32 s34, s34, 1
  v_mov_b32 v6, s34
  s_lshl_b32 s35, s2, 8
  v_lshl_add_u32 v3, v4, 4, s35
  buffer_store_dword v6, v3, s[76:79], 0 offen sc1
  s_waitcnt vmcnt(12)
  ds_write_b128 v4, v[64:67] offset:0
  ds_write_b128 v4, v[68:71] offset:1024
  ds_write_b128 v4, v[72:75] offset:2048
  ds_write_b128 v4, v[76:79] offset:3072
  s_add_u32 s98, s3, 4
  s_and_b32 s98, s98, 7
  s_lshl_b32 s62, s98, 7
  buffer_load_dwordx4 v[128:131], v11, s[40:43], s62 offen
  s_add_u32 s62, s62, 8192
  buffer_load_dwordx4 v[132:135], v12, s[40:43], s62 offen
  s_add_u32 s62, s62, 8192
  buffer_load_dwordx4 v[136:139], v11, s[40:43], s62 offen
  s_add_u32 s62, s62, 8192
  buffer_load_dwordx4 v[140:143], v12, s[40:43], s62 offen
  s_add_u32 s62, s62, 8192
  s_waitcnt lgkmcnt(0)
  s_barrier
  s_waitcnt vmcnt(12)
  ds_write_b128 v4, v[80:83] offset:16384
  ds_write_b128 v4, v[84:87] offset:17408
  ds_write_b128 v4, v[88:91] offset:18432
  ds_write_b128 v4, v[92:95] offset:19456
  s_add_u32 s98, s3, 5
  s_and_b32 s98, s98, 7
  s_lshl_b32 s62, s98, 7
  buffer_load_dwordx4 v[144:147], v11, s[40:43], s62 offen
  s_add_u32 s62, s62, 8192
  buffer_load_dwordx4 v[148:151], v12, s[40:43], s62 offen
  s_add_u32 s62, s62, 8192
  buffer_load_dwordx4 v[152:155], v11, s[40:43], s62 offen
  s_add_u32 s62, s62, 8192
  buffer_load_dwordx4 v[156:159], v12, s[40:43], s62 offen
  s_add_u32 s62, s62, 8192
  s_waitcnt lgkmcnt(0)
  s_barrier
  s_waitcnt vmcnt(12)
  ds_write_b128 v4, v[96:99] offset:32768
  ds_write_b128 v4, v[100:103] offset:33792
  ds_write_b128 v4, v[104:107] offset:34816
  ds_write_b128 v4, v[108:111] offset:35840
  s_add_u32 s98, s3, 6
  s_and_b32 s98, s98, 7
  s_lshl_b32 s62, s98, 7
  buffer_load_dwordx4 v[160:163], v11, s[40:43], s62 offen
  s_add_u32 s62, s62, 8192
  buffer_load_dwordx4 v[164:167], v12, s[40:43], s62 offen
  s_add_u32 s62, s62, 8192
  buffer_load_dwordx4 v[168:171], v11, s[40:43], s62 offen
  s_add_u32 s62, s62, 8192
  buffer_load_dwordx4 v[172:175], v12, s[40:43], s62 offen
  s_add_u32 s62, s62, 8192
  s_waitcnt lgkmcnt(0)
  s_barrier
  s_waitcnt vmcnt(12)
  ds_write_b128 v4, v[112:115] offset:49152
  ds_write_b128 v4, v[116:119] offset:50176
  ds_write_b128 v4, v[120:123] offset:51200
  ds_write_b128 v4, v[124:127] offset:52224
  s_add_u32 s98, s3, 7
  s_and_b32 s98, s98, 7
  s_lshl_b32 s62, s98, 7
  buffer_load_dwordx4 v[176:179], v11, s[40:43], s62 offen
  s_add_u32 s62, s62, 8192
  buffer_load_dwordx4 v[180:183], v12, s[40:43], s62 offen
  s_add_u32 s62, s62, 8192
  buffer_load_dwordx4 v[184:187], v11, s[40:43], s62 offen
  s_add_u32 s62, s62, 8192
  buffer_load_dwordx4 v[188:191], v12, s[40:43], s62 offen
  s_add_u32 s62, s62, 8192
  v_mov_b32 v3, s36
  buffer_load_dword v6, v3, s[76:79], 0 offen sc1
  s_waitcnt lgkmcnt(0)
  s_barrier
  s_waitcnt vmcnt(12)
  ds_write_b128 v4, v[128:131] offset:0
  ds_write_b128 v4, v[132:135] offset:1024
  ds_write_b128 v4, v[136:139] offset:2048
  ds_write_b128 v4, v[140:143] offset:3072
  s_waitcnt lgkmcnt(0)
  s_barrier
  s_waitcnt vmcnt(8)
  ds_write_b128 v4, v[144:147] offset:16384
  ds_write_b128 v4, v[148:151] offset:17408
  ds_write_b128 v4, v[152:155] offset:18432
  ds_write_b128 v4, v[156:159] offset:19456
  s_waitcnt lgkmcnt(0)
  s_barrier
  s_waitcnt vmcnt(4)
  ds_write_b128 v4, v[160:163] offset:32768
  ds_write_b128 v4, v[164:167] offset:33792
  ds_write_b128 v4, v[168:171] offset:34816
  ds_write_b128 v4, v[172:175] offset:35840
  s_waitcnt lgkmcnt(0)
  s_barrier
  s_waitcnt vmcnt(0)
  ds_write_b128 v4, v[176:179] offset:49152
  ds_write_b128 v4, v[180:183] offset:50176
  ds_write_b128 v4, v[184:187] offset:51200
  ds_write_b128 v4, v[188:191] offset:52224
  s_waitcnt lgkmcnt(0)
  s_barrier
  s_cmp_lg_u32 s21, 0
  s_cbranch_scc1 K1_LD1
SP_N:
  v_readfirstlane_b32 s99, v6
  s_cmp_lg_u32 s99, 0
  s_cbranch_scc1 SP_N_OK
  buffer_load_dword v6, v3, s[76:79], 0 offen sc1
  s_add_u32 s97, s97, 1
  s_waitcnt vmcnt(0)
  s_cmp_lt_u32 s97, 0x40000
  s_cbranch_scc1 SP_N
SP_N_OK:
  ds_write_b32 v5, v6
  s_waitcnt lgkmcnt(0)
K1_LD1:
  s_waitcnt vmcnt(0)
  s_barrier
  s_cmp_ge_u32 s23, 2
  s_cbranch_scc0 K1_LD2
  s_barrier
K1_LD2:
  s_barrier
  v_lshlrev_b32 v2, 2, v0
  s_and_b32 s34, s2, 63
  s_lshl_b32 s34, s34, 10
  s_add_u32 s34, s34, 7405568
  v_mul_u32_u24 v5, 1040, v0
  v_add_u32 v5, 66560, v5
  v_mov_b32 v16, 0x3f803f80
  v_mov_b32 v17, 0x3f803f80
  v_mov_b32 v18, 0x3f803f80
  v_mov_b32 v19, 0x3f803f80
  ds_write_b128 v5, v[16:19]
  s_lshl_b32 s22, s74, 1
  s_and_b32 s24, s75, 1
  s_add_u32 s22, s22, s24
  s_lshl_b32 s22, s22, 2
  s_lshr_b32 s24, s75, 1
  s_add_u32 s22, s22, s24
  s_lshl_b32 s22, s22, 13
  s_lshl_b32 s24, s21, 11
  s_add_u32 s22, s22, s24
  s_mul_i32 s26, s21, 4160
  v_mov_b32 v64, 0
  v_mov_b32 v3, 163836
  s_cmp_lg_u32 s21, 0
  s_cbranch_scc1 SP_L
  buffer_load_dword v64, v2, s[56:59], s34 offen sc1
  s_sleep 2
  buffer_load_dword v65, v2, s[56:59], s34 offen sc1
  s_sleep 2
  buffer_load_dword v66, v2, s[56:59], s34 offen sc1
  s_sleep 2
SP_A:
  buffer_load_dword v67, v2, s[56:59], s34 offen sc1
  s_waitcnt vmcnt(3)
  v_cmp_ne_u32 vcc, s99, v64
  s_cbranch_vccz SP_A_OK
  buffer_load_dword v64, v2, s[56:59], s34 offen sc1
  s_waitcnt vmcnt(3)
  v_cmp_ne_u32 vcc, s99, v65
  s_cbranch_vccz SP_A_OK
  buffer_load_dword v65, v2, s[56:59], s34 offen sc1
  s_waitcnt vmcnt(3)
  v_cmp_ne_u32 vcc, s99, v66
  s_cbranch_vccz SP_A_OK
  buffer_load_dword v66, v2, s[56:59], s34 offen sc1
  s_waitcnt vmcnt(3)
  v_cmp_ne_u32 vcc, s99, v67
  s_cbranch_vccz SP_A_OK
  s_add_u32 s97, s97, 1
  s_cmp_lt_u32 s97, 0x40000
  s_cbranch_scc1 SP_A
SP_A_OK:
  ds_write_b32 v3, v3
  s_branch SP_L_OK
SP_L:
  v_cmp_eq_u32 vcc, 0, v64
  s_cbranch_vccz SP_L_OK
  s_sleep 1
  ds_read_b32 v64, v3
  s_waitcnt lgkmcnt(0)
  s_add_u32 s97, s97, 1
  s_waitcnt vmcnt(0)
  s_cmp_lt_u32 s97, 0x40000
  s_cbranch_scc1 SP_L
SP_L_OK:
  s_add_u32 m0, s24, 151552
  s_add_u32 s27, s22, 0
  buffer_load_dwordx4 v13, s[56:59], s27 offen sc1 lds
  s_add_u32 m0, s24, 152576
  s_add_u32 s27, s22, 1024
  buffer_load_dwordx4 v13, s[56:59], s27 offen sc1 lds
  s_add_u32 m0, s36, 0
  s_add_u32 s27, s36, 4194304
  buffer_load_dwordx4 v13, s[56:59], s27 offen sc1 lds
  s_add_u32 m0, s26, 65536
  s_add_u32 s27, s36, 4259840
  buffer_load_dwordx4 v13, s[56:59], s27 offen sc1 lds
  s_add_u32 m0, s36, 1024
  s_add_u32 s27, s36, 4195328
  buffer_load_dwordx4 v13, s[56:59], s27 offen sc1 lds
  s_add_u32 m0, s26, 66576
  s_add_u32 s27, s36, 4260864
  buffer_load_dwordx4 v13, s[56:59], s27 offen sc1 lds
  s_add_u32 m0, s36, 2048
  s_add_u32 s27, s36, 4196352
  buffer_load_dwordx4 v13, s[56:59], s27 offen sc1 lds
  s_add_u32 m0, s26, 67616
  s_add_u32 s27, s36, 4261888
  buffer_load_dwordx4 v13, s[56:59], s27 offen sc1 lds
  s_add_u32 m0, s36, 3072
  s_add_u32 s27, s36, 4197376
  buffer_load_dwordx4 v13, s[56:59], s27 offen sc1 lds
  s_add_u32 m0, s26, 68656
  s_add_u32 s27, s36, 4262912
  buffer_load_dwordx4 v13, s[56:59], s27 offen sc1 lds
K2_START:
  s_load_dwordx2 s[4:5], s[0:1], 32
  s_load_dwordx4 s[8:11], s[0:1], 64
  s_mov_b32 s21, s67
  s_lshl_b32 s22, s74, 1
  s_and_b32 s24, s75, 1
  s_add_u32 s22, s22, s24
  s_lshl_b32 s22, s22, 2
  s_lshr_b32 s24, s75, 1
  s_add_u32 s22, s22, s24
  s_lshl_b32 s22, s22, 3
  s_add_u32 s22, s22, s21
  s_lshl_b32 s22, s22, 10
  s_lshl_b32 s24, s75, 3
  s_add_u32 s24, s24, s21
  s_lshl_b32 s24, s24, 5
  s_add_u32 s24, s24, s74
  s_lshl_b32 s24, s24, 10
  v_and_b32 v2, 15, v0
  v_lshrrev_b32 v3, 5, v0
  v_lshl_add_u32 v4, v3, 6, v2
  v_lshlrev_b32 v14, 1, v4
  v_lshlrev_b32 v12, 3, v0
  v_bfe_u32 v6, v0, 4, 1
  v_cmp_eq_u32 s[70:71], 1, v6
  v_lshl_add_u32 v7, v3, 4, v2
  v_lshlrev_b32 v7, 4, v7
  v_add_u32 v8, 512, v7
  v_mov_b32 v9, 1024
  v_cndmask_b32 v10, v7, v9, s[70:71]
  v_cndmask_b32 v11, v8, v9, s[70:71]
  v_add_u32 v10, 65536, v10
  v_add_u32 v11, 65536, v11
  v_mul_u32_u24 v9, 0x8000, v6
  v_lshl_or_b32 v9, v9, 16, v9
  v_mov_b32 v15, 0xdddddddd
  s_mov_b32 s72, 1069066811
  s_mov_b32 s73, 1069066811
  s_lshl_b32 s27, s21, 10
  s_add_u32 s27, s27, 151552
  v_add_u32 v2, s27, v13
  v_mov_b32 v1, 163832
  ds_read_b32 v1, v1
  s_and_b32 s28, s2, 63
  s_lshl_b32 s28, s28, 10
  s_add_u32 s28, s28, 7405568
  v_mov_b32 v48, 0
  v_mov_b32 v49, 0
  v_mov_b32 v50, 0
  v_mov_b32 v51, 0
  v_mov_b32 v52, 0
  v_mov_b32 v53, 0
  v_mov_b32 v54, 0
  v_mov_b32 v55, 0
  v_mov_b32 v56, 0
  v_mov_b32 v57, 0
  v_mov_b32 v58, 0
  v_mov_b32 v59, 0
  v_mov_b32 v60, 0
  v_mov_b32 v61, 0
  v_mov_b32 v62, 0
  v_mov_b32 v63, 0
  s_cmp_lt_u32 s21, 4
  s_cbranch_scc1 K2_E
  s_waitcnt vmcnt(0)
K2_E:
  s_waitcnt lgkmcnt(0)
  s_barrier
  v_readfirstlane_b32 s99, v1
  s_mov_b32 s40, s4
  s_mov_b32 s41, s5
  s_mov_b32 s42, 524288
  s_mov_b32 s43, 0x00020000
  s_mov_b32 s44, s8
  s_mov_b32 s45, s9
  s_mov_b32 s46, 524288
  s_mov_b32 s47, 0x00020000
  s_mov_b32 s48, s10
  s_mov_b32 s49, s11
  s_mov_b32 s50, 4194304
  s_mov_b32 s51, 0x00020000
  ds_read_b128 v[80:83], v2
  ds_read_b128 v[84:87], v13 offset:0
  s_waitcnt lgkmcnt(0)
  v_mfma_f32_32x32x16_bf16 v[16:31], v[84:87], v[80:83], 0
  ds_read_b128 v[84:87], v13 offset:1024
  ds_read_b128 v[88:91], v10 offset:0
  s_nop 7
  s_nop 1
  s_lshl_b32 s60, s21, 11
  s_mul_i32 s61, s21, 2080
  s_setprio 3
  v_exp_f32 v16, v16
  v_exp_f32 v17, v17
  ds_read_b128 v[92:95], v11 offset:0
  s_add_u32 m0, s60, 16384
  s_add_u32 s27, s60, 4210688
  buffer_load_dwordx4 v13, s[56:59], s27 offen sc1 lds
  v_exp_f32 v18, v18
  v_exp_f32 v19, v19
  v_exp_f32 v20, v20
  s_waitcnt lgkmcnt(2)
  v_mfma_f32_32x32x16_bf16 v[32:47], v[84:87], v[80:83], 0
  ds_read_b128 v[84:87], v13 offset:2048
  s_add_u32 m0, s61, 82176
  s_add_u32 s27, s60, 4276224
  buffer_load_dwordx4 v13, s[56:59], s27 offen sc1 lds
  v_exp_f32 v21, v21
  v_exp_f32 v22, v22
  v_exp_f32 v23, v23
  v_exp_f32 v24, v24
  v_exp_f32 v25, v25
  s_waitcnt lgkmcnt(2)
  v_smfmac_f32_32x32x32_bf16 v[48:63], v[88:91], v[16:23], v15
  ds_read_b128 v[88:91], v10 offset:1040
  v_exp_f32 v26, v26
  v_exp_f32 v27, v27
  v_exp_f32 v28, v28
  v_exp_f32 v29, v29
  v_exp_f32 v30, v30
  v_exp_f32 v31, v31
  v_exp_f32 v32, v32
  v_exp_f32 v33, v33
  s_waitcnt lgkmcnt(2)
  v_smfmac_f32_32x32x32_bf16 v[48:63], v[92:95], v[24:31], v15
  ds_read_b128 v[92:95], v11 offset:1040
  s_add_u32 m0, s60, 17408
  s_add_u32 s27, s60, 4211712
  buffer_load_dwordx4 v13, s[56:59], s27 offen sc1 lds
  v_exp_f32 v34, v34
  v_exp_f32 v35, v35
  v_exp_f32 v36, v36
  s_waitcnt lgkmcnt(2)
  v_mfma_f32_32x32x16_bf16 v[16:31], v[84:87], v[80:83], 0
  ds_read_b128 v[84:87], v13 offset:3072
  s_add_u32 m0, s61, 83216
  s_add_u32 s27, s60, 4277248
  buffer_load_dwordx4 v13, s[56:59], s27 offen sc1 lds
  v_exp_f32 v37, v37
  v_exp_f32 v38, v38
  v_exp_f32 v39, v39
  v_exp_f32 v40, v40
  v_exp_f32 v41, v41
  s_waitcnt lgkmcnt(2)
  v_smfmac_f32_32x32x32_bf16 v[48:63], v[88:91], v[32:39], v15
  ds_read_b128 v[88:91], v10 offset:2080
  v_exp_f32 v42, v42
  v_exp_f32 v43, v43
  v_exp_f32 v44, v44
  v_exp_f32 v45, v45
  v_exp_f32 v46, v46
  v_exp_f32 v47, v47
  v_exp_f32 v16, v16
  v_exp_f32 v17, v17
  s_waitcnt lgkmcnt(2)
  v_smfmac_f32_32x32x32_bf16 v[48:63], v[92:95], v[40:47], v15
  ds_read_b128 v[92:95], v11 offset:2080
  s_add_u32 m0, s60, 32768
  s_add_u32 s27, s60, 4227072
  buffer_load_dwordx4 v13, s[56:59], s27 offen sc1 lds
  v_exp_f32 v18, v18
  v_exp_f32 v19, v19
  v_exp_f32 v20, v20
  s_waitcnt lgkmcnt(2)
  v_mfma_f32_32x32x16_bf16 v[32:47], v[84:87], v[80:83], 0
  ds_read_b128 v[84:87], v13 offset:4096
  s_add_u32 m0, s61, 98816
  s_add_u32 s27, s60, 4292608
  buffer_load_dwordx4 v13, s[56:59], s27 offen sc1 lds
  v_exp_f32 v21, v21
  v_exp_f32 v22, v22
  v_exp_f32 v23, v23
  v_exp_f32 v24, v24
  v_exp_f32 v25, v25
  s_waitcnt lgkmcnt(2)
  v_smfmac_f32_32x32x32_bf16 v[48:63], v[88:91], v[16:23], v15
  ds_read_b128 v[88:91], v10 offset:3120
  v_exp_f32 v26, v26
  v_exp_f32 v27, v27
  v_exp_f32 v28, v28
  v_exp_f32 v29, v29
  v_exp_f32 v30, v30
  v_exp_f32 v31, v31
  v_exp_f32 v32, v32
  v_exp_f32 v33, v33
  s_waitcnt lgkmcnt(2)
  v_smfmac_f32_32x32x32_bf16 v[48:63], v[92:95], v[24:31], v15
  ds_read_b128 v[92:95], v11 offset:3120
  s_add_u32 m0, s60, 33792
  s_add_u32 s27, s60, 4228096
  buffer_load_dwordx4 v13, s[56:59], s27 offen sc1 lds
  v_exp_f32 v34, v34
  v_exp_f32 v35, v35
  v_exp_f32 v36, v36
  s_waitcnt lgkmcnt(2)
  v_mfma_f32_32x32x16_bf16 v[16:31], v[84:87], v[80:83], 0
  ds_read_b128 v[84:87], v13 offset:5120
  s_add_u32 m0, s61, 99856
  s_add_u32 s27, s60, 4293632
  buffer_load_dwordx4 v13, s[56:59], s27 offen sc1 lds
  v_exp_f32 v37, v37
  v_exp_f32 v38, v38
  v_exp_f32 v39, v39
  v_exp_f32 v40, v40
  v_exp_f32 v41, v41
  s_waitcnt lgkmcnt(2)
  v_smfmac_f32_32x32x32_bf16 v[48:63], v[88:91], v[32:39], v15
  ds_read_b128 v[88:91], v10 offset:4160
  v_exp_f32 v42, v42
  v_exp_f32 v43, v43
  v_exp_f32 v44, v44
  v_exp_f32 v45, v45
  v_exp_f32 v46, v46
  v_exp_f32 v47, v47
  v_exp_f32 v16, v16
  v_exp_f32 v17, v17
  s_waitcnt lgkmcnt(2)
  v_smfmac_f32_32x32x32_bf16 v[48:63], v[92:95], v[40:47], v15
  ds_read_b128 v[92:95], v11 offset:4160
  s_add_u32 m0, s60, 49152
  s_add_u32 s27, s60, 4243456
  buffer_load_dwordx4 v13, s[56:59], s27 offen sc1 lds
  v_exp_f32 v18, v18
  v_exp_f32 v19, v19
  v_exp_f32 v20, v20
  s_waitcnt lgkmcnt(2)
  v_mfma_f32_32x32x16_bf16 v[32:47], v[84:87], v[80:83], 0
  ds_read_b128 v[84:87], v13 offset:6144
  s_add_u32 m0, s61, 115456
  s_add_u32 s27, s60, 4308992
  buffer_load_dwordx4 v13, s[56:59], s27 offen sc1 lds
  v_exp_f32 v21, v21
  v_exp_f32 v22, v22
  v_exp_f32 v23, v23
  v_exp_f32 v24, v24
  v_exp_f32 v25, v25
  s_waitcnt lgkmcnt(2)
  v_smfmac_f32_32x32x32_bf16 v[48:63], v[88:91], v[16:23], v15
  ds_read_b128 v[88:91], v10 offset:5200
  v_exp_f32 v26, v26
  v_exp_f32 v27, v27
  v_exp_f32 v28, v28
  v_exp_f32 v29, v29
  v_exp_f32 v30, v30
  v_exp_f32 v31, v31
  v_exp_f32 v32, v32
  v_exp_f32 v33, v33
  s_waitcnt lgkmcnt(2)
  v_smfmac_f32_32x32x32_bf16 v[48:63], v[92:95], v[24:31], v15
  ds_read_b128 v[92:95], v11 offset:5200
  s_add_u32 m0, s60, 50176
  s_add_u32 s27, s60, 4244480
  buffer_load_dwordx4 v13, s[56:59], s27 offen sc1 lds
  v_exp_f32 v34, v34
  v_exp_f32 v35, v35
  v_exp_f32 v36, v36
  s_waitcnt lgkmcnt(2)
  v_mfma_f32_32x32x16_bf16 v[16:31], v[84:87], v[80:83], 0
  ds_read_b128 v[84:87], v13 offset:7168
  s_add_u32 m0, s61, 116496
  s_add_u32 s27, s60, 4310016
  buffer_load_dwordx4 v13, s[56:59], s27 offen sc1 lds
  v_exp_f32 v37, v37
  v_exp_f32 v38, v38
  v_exp_f32 v39, v39
  v_exp_f32 v40, v40
  v_exp_f32 v41, v41
  s_waitcnt lgkmcnt(2)
  v_smfmac_f32_32x32x32_bf16 v[48:63], v[88:91], v[32:39], v15
  ds_read_b128 v[88:91], v10 offset:6240
  v_exp_f32 v42, v42
  v_exp_f32 v43, v43
  v_exp_f32 v44, v44
  v_exp_f32 v45, v45
  v_exp_f32 v46, v46
  v_exp_f32 v47, v47
  s_setprio 2
  buffer_load_dwordx4 v[64:67], v13, s[56:59], s28 offen sc1
  v_exp_f32 v16, v16
  v_exp_f32 v17, v17
  s_waitcnt lgkmcnt(2)
  v_smfmac_f32_32x32x32_bf16 v[48:63], v[92:95], v[40:47], v15
  ds_read_b128 v[92:95], v11 offset:6240
  v_exp_f32 v18, v18
  v_exp_f32 v19, v19
  v_exp_f32 v20, v20
  s_waitcnt lgkmcnt(2)
  v_mfma_f32_32x32x16_bf16 v[32:47], v[84:87], v[80:83], 0
  ds_read_b128 v[84:87], v13 offset:8192
  v_exp_f32 v21, v21
  v_exp_f32 v22, v22
  v_exp_f32 v23, v23
  v_exp_f32 v24, v24
  v_exp_f32 v25, v25
  s_waitcnt lgkmcnt(2)
  v_smfmac_f32_32x32x32_bf16 v[48:63], v[88:91], v[16:23], v15
  ds_read_b128 v[88:91], v10 offset:7280
  v_exp_f32 v26, v26
  v_exp_f32 v27, v27
  v_exp_f32 v28, v28
  v_exp_f32 v29, v29
  v_exp_f32 v30, v30
  v_exp_f32 v31, v31
  v_exp_f32 v32, v32
  v_exp_f32 v33, v33
  s_waitcnt lgkmcnt(2)
  v_smfmac_f32_32x32x32_bf16 v[48:63], v[92:95], v[24:31], v15
  ds_read_b128 v[92:95], v11 offset:7280
  v_exp_f32 v34, v34
  v_exp_f32 v35, v35
  v_exp_f32 v36, v36
  s_waitcnt lgkmcnt(2)
  v_mfma_f32_32x32x16_bf16 v[16:31], v[84:87], v[80:83], 0
  ds_read_b128 v[84:87], v13 offset:9216
  v_exp_f32 v37, v37
  v_exp_f32 v38, v38
  v_exp_f32 v39, v39
  v_exp_f32 v40, v40
  v_exp_f32 v41, v41
  s_waitcnt lgkmcnt(2)
  v_smfmac_f32_32x32x32_bf16 v[48:63], v[88:91], v[32:39], v15
  ds_read_b128 v[88:91], v10 offset:8320
  v_exp_f32 v42, v42
  v_exp_f32 v43, v43
  v_exp_f32 v44, v44
  v_exp_f32 v45, v45
  v_exp_f32 v46, v46
  v_exp_f32 v47, v47
  v_exp_f32 v16, v16
  v_exp_f32 v17, v17
  s_waitcnt lgkmcnt(2)
  v_smfmac_f32_32x32x32_bf16 v[48:63], v[92:95], v[40:47], v15
  ds_read_b128 v[92:95], v11 offset:8320
  v_exp_f32 v18, v18
  v_exp_f32 v19, v19
  v_exp_f32 v20, v20
  s_waitcnt lgkmcnt(2)
  v_mfma_f32_32x32x16_bf16 v[32:47], v[84:87], v[80:83], 0
  ds_read_b128 v[84:87], v13 offset:10240
  v_exp_f32 v21, v21
  v_exp_f32 v22, v22
  v_exp_f32 v23, v23
  v_exp_f32 v24, v24
  v_exp_f32 v25, v25
  s_waitcnt lgkmcnt(2)
  v_smfmac_f32_32x32x32_bf16 v[48:63], v[88:91], v[16:23], v15
  ds_read_b128 v[88:91], v10 offset:9360
  v_exp_f32 v26, v26
  v_exp_f32 v27, v27
  v_exp_f32 v28, v28
  v_exp_f32 v29, v29
  v_exp_f32 v30, v30
  v_exp_f32 v31, v31
  v_exp_f32 v32, v32
  v_exp_f32 v33, v33
  s_waitcnt lgkmcnt(2)
  v_smfmac_f32_32x32x32_bf16 v[48:63], v[92:95], v[24:31], v15
  ds_read_b128 v[92:95], v11 offset:9360
  v_exp_f32 v34, v34
  v_exp_f32 v35, v35
  v_exp_f32 v36, v36
  s_waitcnt lgkmcnt(2)
  v_mfma_f32_32x32x16_bf16 v[16:31], v[84:87], v[80:83], 0
  ds_read_b128 v[84:87], v13 offset:11264
  v_exp_f32 v37, v37
  v_exp_f32 v38, v38
  v_exp_f32 v39, v39
  v_exp_f32 v40, v40
  v_exp_f32 v41, v41
  s_waitcnt lgkmcnt(2)
  v_smfmac_f32_32x32x32_bf16 v[48:63], v[88:91], v[32:39], v15
  ds_read_b128 v[88:91], v10 offset:10400
  v_exp_f32 v42, v42
  v_exp_f32 v43, v43
  v_exp_f32 v44, v44
  v_exp_f32 v45, v45
  v_exp_f32 v46, v46
  v_exp_f32 v47, v47
  s_setprio 1
  s_waitcnt vmcnt(0)
SP_B:
  v_xor_b32 v64, s99, v64
  v_xor_b32 v65, s99, v65
  v_xor_b32 v66, s99, v66
  v_xor_b32 v67, s99, v67
  v_or3_b32 v64, v64, v65, v66
  v_or_b32 v64, v64, v67
  v_cmp_ne_u32 vcc, 0, v64
  s_cbranch_vccz SP_B_OK
  s_sleep 1
  buffer_load_dwordx4 v[64:67], v13, s[56:59], s28 offen sc1
  s_add_u32 s97, s97, 1
  s_waitcnt vmcnt(0)
  s_cmp_lt_u32 s97, 0x40000
  s_cbranch_scc1 SP_B
SP_B_OK:
  s_add_u32 s27, s24, 2097152
  buffer_load_dwordx4 v[96:99], v13, s[56:59], s27 offen sc1
  s_lshl_b32 s62, s74, 9
  s_lshl_b32 s27, s74, 16
  s_lshl_b32 s28, s21, 9
  s_add_u32 s27, s27, s28
  s_add_u32 s27, s27, 5242880
  v_lshrrev_b32 v2, 3, v0
  v_and_b32 v3, 7, v0
  v_lshlrev_b32 v4, 2, v6
  v_xor_b32 v3, v3, v4
  v_lshlrev_b32 v3, 4, v3
  v_lshl_add_u32 v4, v2, 10, v3
  s_lshl_b32 s64, s21, 16
  s_lshl_b32 s28, s75, 7
  s_add_u32 s64, s64, s28
  s_lshr_b32 s30, s21, 2
  s_lshl_b32 s31, s30, 16
  s_and_b32 s25, s21, 3
  s_lshl_b32 s25, s25, 13
  s_add_u32 s25, s25, s31
  s_lshl_b32 s26, s30, 9
  s_add_u32 s26, s26, 32768
  v_exp_f32 v16, v16
  v_exp_f32 v17, v17
  s_waitcnt lgkmcnt(2)
  v_smfmac_f32_32x32x32_bf16 v[48:63], v[92:95], v[40:47], v15
  ds_read_b128 v[92:95], v11 offset:10400
  v_exp_f32 v18, v18
  v_exp_f32 v19, v19
  v_exp_f32 v20, v20
  s_waitcnt lgkmcnt(2)
  v_mfma_f32_32x32x16_bf16 v[32:47], v[84:87], v[80:83], 0
  ds_read_b128 v[84:87], v13 offset:12288
  v_exp_f32 v21, v21
  v_exp_f32 v22, v22
  v_exp_f32 v23, v23
  v_exp_f32 v24, v24
  v_exp_f32 v25, v25
  s_waitcnt lgkmcnt(2)
  v_smfmac_f32_32x32x32_bf16 v[48:63], v[88:91], v[16:23], v15
  ds_read_b128 v[88:91], v10 offset:11440
  v_exp_f32 v26, v26
  v_exp_f32 v27, v27
  v_exp_f32 v28, v28
  v_exp_f32 v29, v29
  v_exp_f32 v30, v30
  v_exp_f32 v31, v31
  v_exp_f32 v32, v32
  v_exp_f32 v33, v33
  s_waitcnt lgkmcnt(2)
  v_smfmac_f32_32x32x32_bf16 v[48:63], v[92:95], v[24:31], v15
  ds_read_b128 v[92:95], v11 offset:11440
  buffer_load_dwordx2 v[104:105], v12, s[56:59], s27 offen sc1
  s_add_u32 s27, s27, 4096
  v_exp_f32 v34, v34
  v_exp_f32 v35, v35
  v_exp_f32 v36, v36
  s_waitcnt lgkmcnt(2)
  v_mfma_f32_32x32x16_bf16 v[16:31], v[84:87], v[80:83], 0
  ds_read_b128 v[84:87], v13 offset:13312
  buffer_load_dwordx2 v[106:107], v12, s[56:59], s27 offen sc1
  s_add_u32 s27, s27, 4096
  v_exp_f32 v37, v37
  v_exp_f32 v38, v38
  v_exp_f32 v39, v39
  v_exp_f32 v40, v40
  v_exp_f32 v41, v41
  s_waitcnt lgkmcnt(2)
  v_smfmac_f32_32x32x32_bf16 v[48:63], v[88:91], v[32:39], v15
  ds_read_b128 v[88:91], v10 offset:12480
  s_add_u32 s65, s64, 0
  buffer_load_dwordx4 v[192:195], v4, s[40:43], s65 offen
  v_exp_f32 v42, v42
  v_exp_f32 v43, v43
  v_exp_f32 v44, v44
  v_exp_f32 v45, v45
  v_exp_f32 v46, v46
  v_exp_f32 v47, v47
  s_setprio 0
  v_exp_f32 v16, v16
  v_exp_f32 v17, v17
  s_waitcnt lgkmcnt(2)
  v_smfmac_f32_32x32x32_bf16 v[48:63], v[92:95], v[40:47], v15
  ds_read_b128 v[92:95], v11 offset:12480
  buffer_load_dwordx2 v[108:109], v12, s[56:59], s27 offen sc1
  s_add_u32 s27, s27, 4096
  v_exp_f32 v18, v18
  v_exp_f32 v19, v19
  v_exp_f32 v20, v20
  s_waitcnt lgkmcnt(2)
  v_mfma_f32_32x32x16_bf16 v[32:47], v[84:87], v[80:83], 0
  ds_read_b128 v[84:87], v13 offset:14336
  buffer_load_dwordx2 v[110:111], v12, s[56:59], s27 offen sc1
  s_add_u32 s27, s27, 4096
  v_exp_f32 v21, v21
  v_exp_f32 v22, v22
  v_exp_f32 v23, v23
  v_exp_f32 v24, v24
  v_exp_f32 v25, v25
  s_waitcnt lgkmcnt(2)
  v_smfmac_f32_32x32x32_bf16 v[48:63], v[88:91], v[16:23], v15
  ds_read_b128 v[88:91], v10 offset:13520
  s_add_u32 s65, s64, 8192
  buffer_load_dwordx4 v[196:199], v4, s[40:43], s65 offen
  v_exp_f32 v26, v26
  v_exp_f32 v27, v27
  v_exp_f32 v28, v28
  v_exp_f32 v29, v29
  v_exp_f32 v30, v30
  v_exp_f32 v31, v31
  v_exp_f32 v32, v32
  v_exp_f32 v33, v33
  s_waitcnt lgkmcnt(2)
  v_smfmac_f32_32x32x32_bf16 v[48:63], v[92:95], v[24:31], v15
  ds_read_b128 v[92:95], v11 offset:13520
  buffer_load_dwordx2 v[112:113], v12, s[56:59], s27 offen sc1
  s_add_u32 s27, s27, 4096
  v_exp_f32 v34, v34
  v_exp_f32 v35, v35
  v_exp_f32 v36, v36
  s_waitcnt lgkmcnt(2)
  v_mfma_f32_32x32x16_bf16 v[16:31], v[84:87], v[80:83], 0
  ds_read_b128 v[84:87], v13 offset:15360
  buffer_load_dwordx2 v[114:115], v12, s[56:59], s27 offen sc1
  s_add_u32 s27, s27, 4096
  v_exp_f32 v37, v37
  v_exp_f32 v38, v38
  v_exp_f32 v39, v39
  v_exp_f32 v40, v40
  v_exp_f32 v41, v41
  s_waitcnt lgkmcnt(2)
  v_smfmac_f32_32x32x32_bf16 v[48:63], v[88:91], v[32:39], v15
  ds_read_b128 v[88:91], v10 offset:14560
  s_add_u32 s65, s64, 16384
  buffer_load_dwordx4 v[200:203], v4, s[40:43], s65 offen
  v_exp_f32 v42, v42
  v_exp_f32 v43, v43
  v_exp_f32 v44, v44
  v_exp_f32 v45, v45
  v_exp_f32 v46, v46
  v_exp_f32 v47, v47
  s_setprio 3
  s_barrier
  v_exp_f32 v16, v16
  v_exp_f32 v17, v17
  s_waitcnt lgkmcnt(2)
  v_smfmac_f32_32x32x32_bf16 v[48:63], v[92:95], v[40:47], v15
  ds_read_b128 v[92:95], v11 offset:14560
  buffer_load_dwordx2 v[116:117], v12, s[56:59], s27 offen sc1
  s_add_u32 s27, s27, 4096
  v_exp_f32 v18, v18
  v_exp_f32 v19, v19
  v_exp_f32 v20, v20
  s_waitcnt lgkmcnt(2)
  v_mfma_f32_32x32x16_bf16 v[32:47], v[84:87], v[80:83], 0
  ds_read_b128 v[84:87], v13 offset:16384
  buffer_load_dwordx2 v[118:119], v12, s[56:59], s27 offen sc1
  s_add_u32 s27, s27, 4096
  v_exp_f32 v21, v21
  v_exp_f32 v22, v22
  v_exp_f32 v23, v23
  v_exp_f32 v24, v24
  v_exp_f32 v25, v25
  s_waitcnt lgkmcnt(2)
  v_smfmac_f32_32x32x32_bf16 v[48:63], v[88:91], v[16:23], v15
  ds_read_b128 v[88:91], v10 offset:15600
  s_add_u32 s65, s64, 24576
  buffer_load_dwordx4 v[204:207], v4, s[40:43], s65 offen
  v_exp_f32 v26, v26
  v_exp_f32 v27, v27
  v_exp_f32 v28, v28
  v_exp_f32 v29, v29
  v_exp_f32 v30, v30
  v_exp_f32 v31, v31
  v_exp_f32 v32, v32
  v_exp_f32 v33, v33
  s_waitcnt lgkmcnt(2)
  v_smfmac_f32_32x32x32_bf16 v[48:63], v[92:95], v[24:31], v15
  ds_read_b128 v[92:95], v11 offset:15600
  buffer_load_dwordx2 v[120:121], v12, s[56:59], s27 offen sc1
  s_add_u32 s27, s27, 4096
  v_exp_f32 v34, v34
  v_exp_f32 v35, v35
  v_exp_f32 v36, v36
  s_waitcnt lgkmcnt(2)
  v_mfma_f32_32x32x16_bf16 v[16:31], v[84:87], v[80:83], 0
  ds_read_b128 v[84:87], v13 offset:17408
  buffer_load_dwordx2 v[122:123], v12, s[56:59], s27 offen sc1
  s_add_u32 s27, s27, 4096
  v_exp_f32 v37, v37
  v_exp_f32 v38, v38
  v_exp_f32 v39, v39
  v_exp_f32 v40, v40
  v_exp_f32 v41, v41
  s_waitcnt lgkmcnt(2)
  v_smfmac_f32_32x32x32_bf16 v[48:63], v[88:91], v[32:39], v15
  ds_read_b128 v[88:91], v10 offset:16640
  s_add_u32 s65, s64, 32768
  buffer_load_dwordx4 v[208:211], v4, s[40:43], s65 offen
  v_exp_f32 v42, v42
  v_exp_f32 v43, v43
  v_exp_f32 v44, v44
  v_exp_f32 v45, v45
  v_exp_f32 v46, v46
  v_exp_f32 v47, v47
  v_exp_f32 v16, v16
  v_exp_f32 v17, v17
  s_waitcnt lgkmcnt(2)
  v_smfmac_f32_32x32x32_bf16 v[48:63], v[92:95], v[40:47], v15
  ds_read_b128 v[92:95], v11 offset:16640
  buffer_load_dwordx2 v[124:125], v12, s[56:59], s27 offen sc1
  s_add_u32 s27, s27, 4096
  v_exp_f32 v18, v18
  v_exp_f32 v19, v19
  v_exp_f32 v20, v20
  s_waitcnt lgkmcnt(2)
  v_mfma_f32_32x32x16_bf16 v[32:47], v[84:87], v[80:83], 0
  ds_read_b128 v[84:87], v13 offset:18432
  buffer_load_dwordx2 v[126:127], v12, s[56:59], s27 offen sc1
  s_add_u32 s27, s27, 4096
  v_exp_f32 v21, v21
  v_exp_f32 v22, v22
  v_exp_f32 v23, v23
  v_exp_f32 v24, v24
  v_exp_f32 v25, v25
  s_waitcnt lgkmcnt(2)
  v_smfmac_f32_32x32x32_bf16 v[48:63], v[88:91], v[16:23], v15
  ds_read_b128 v[88:91], v10 offset:17680
  s_add_u32 s65, s64, 40960
  buffer_load_dwordx4 v[212:215], v4, s[40:43], s65 offen
  v_exp_f32 v26, v26
  v_exp_f32 v27, v27
  v_exp_f32 v28, v28
  v_exp_f32 v29, v29
  v_exp_f32 v30, v30
  v_exp_f32 v31, v31
  v_exp_f32 v32, v32
  v_exp_f32 v33, v33
  s_waitcnt lgkmcnt(2)
  v_smfmac_f32_32x32x32_bf16 v[48:63], v[92:95], v[24:31], v15
  ds_read_b128 v[92:95], v11 offset:17680
  buffer_load_dwordx2 v[128:129], v12, s[56:59], s27 offen sc1
  s_add_u32 s27, s27, 4096
  v_exp_f32 v34, v34
  v_exp_f32 v35, v35
  v_exp_f32 v36, v36
  s_waitcnt lgkmcnt(2)
  v_mfma_f32_32x32x16_bf16 v[16:31], v[84:87], v[80:83], 0
  ds_read_b128 v[84:87], v13 offset:19456
  buffer_load_dwordx2 v[130:131], v12, s[56:59], s27 offen sc1
  s_add_u32 s27, s27, 4096
  v_exp_f32 v37, v37
  v_exp_f32 v38, v38
  v_exp_f32 v39, v39
  v_exp_f32 v40, v40
  v_exp_f32 v41, v41
  s_waitcnt lgkmcnt(2)
  v_smfmac_f32_32x32x32_bf16 v[48:63], v[88:91], v[32:39], v15
  ds_read_b128 v[88:91], v10 offset:18720
  s_add_u32 s65, s64, 49152
  buffer_load_dwordx4 v[216:219], v4, s[40:43], s65 offen
  v_exp_f32 v42, v42
  v_exp_f32 v43, v43
  v_exp_f32 v44, v44
  v_exp_f32 v45, v45
  v_exp_f32 v46, v46
  v_exp_f32 v47, v47
  v_exp_f32 v16, v16
  v_exp_f32 v17, v17
  s_waitcnt lgkmcnt(2)
  v_smfmac_f32_32x32x32_bf16 v[48:63], v[92:95], v[40:47], v15
  ds_read_b128 v[92:95], v11 offset:18720
  buffer_load_dwordx2 v[132:133], v12, s[56:59], s27 offen sc1
  s_add_u32 s27, s27, 4096
  v_exp_f32 v18, v18
  v_exp_f32 v19, v19
  v_exp_f32 v20, v20
  s_waitcnt lgkmcnt(2)
  v_mfma_f32_32x32x16_bf16 v[32:47], v[84:87], v[80:83], 0
  ds_read_b128 v[84:87], v13 offset:20480
  buffer_load_dwordx2 v[134:135], v12, s[56:59], s27 offen sc1
  s_add_u32 s27, s27, 4096
  v_exp_f32 v21, v21
  v_exp_f32 v22, v22
  v_exp_f32 v23, v23
  v_exp_f32 v24, v24
  v_exp_f32 v25, v25
  s_waitcnt lgkmcnt(2)
  v_smfmac_f32_32x32x32_bf16 v[48:63], v[88:91], v[16:23], v15
  ds_read_b128 v[88:91], v10 offset:19760
  s_add_u32 s65, s64, 57344
  buffer_load_dwordx4 v[220:223], v4, s[40:43], s65 offen
  v_exp_f32 v26, v26
  v_exp_f32 v27, v27
  v_exp_f32 v28, v28
  v_exp_f32 v29, v29
  v_exp_f32 v30, v30
  v_exp_f32 v31, v31
  v_exp_f32 v32, v32
  v_exp_f32 v33, v33
  s_waitcnt lgkmcnt(2)
  v_smfmac_f32_32x32x32_bf16 v[48:63], v[92:95], v[24:31], v15
  ds_read_b128 v[92:95], v11 offset:19760
  buffer_load_ushort v136, v14, s[52:55], s62 offen offset:0
  v_exp_f32 v34, v34
  v_exp_f32 v35, v35
  v_exp_f32 v36, v36
  s_waitcnt lgkmcnt(2)
  v_mfma_f32_32x32x16_bf16 v[16:31], v[84:87], v[80:83], 0
  ds_read_b128 v[84:87], v13 offset:21504
  buffer_load_ushort v137, v14, s[52:55], s62 offen offset:32
  v_exp_f32 v37, v37
  v_exp_f32 v38, v38
  v_exp_f32 v39, v39
  v_exp_f32 v40, v40
  v_exp_f32 v41, v41
  s_waitcnt lgkmcnt(2)
  v_smfmac_f32_32x32x32_bf16 v[48:63], v[88:91], v[32:39], v15
  ds_read_b128 v[88:91], v10 offset:20800
  v_exp_f32 v42, v42
  v_exp_f32 v43, v43
  v_exp_f32 v44, v44
  v_exp_f32 v45, v45
  v_exp_f32 v46, v46
  v_exp_f32 v47, v47
  v_exp_f32 v16, v16
  v_exp_f32 v17, v17
  s_waitcnt lgkmcnt(2)
  v_smfmac_f32_32x32x32_bf16 v[48:63], v[92:95], v[40:47], v15
  ds_read_b128 v[92:95], v11 offset:20800
  buffer_load_ushort v138, v14, s[52:55], s62 offen offset:64
  v_exp_f32 v18, v18
  v_exp_f32 v19, v19
  v_exp_f32 v20, v20
  s_waitcnt lgkmcnt(2)
  v_mfma_f32_32x32x16_bf16 v[32:47], v[84:87], v[80:83], 0
  ds_read_b128 v[84:87], v13 offset:22528
  buffer_load_ushort v139, v14, s[52:55], s62 offen offset:96
  v_exp_f32 v21, v21
  v_exp_f32 v22, v22
  v_exp_f32 v23, v23
  v_exp_f32 v24, v24
  v_exp_f32 v25, v25
  s_waitcnt lgkmcnt(2)
  v_smfmac_f32_32x32x32_bf16 v[48:63], v[88:91], v[16:23], v15
  ds_read_b128 v[88:91], v10 offset:21840
  v_exp_f32 v26, v26
  v_exp_f32 v27, v27
  v_exp_f32 v28, v28
  v_exp_f32 v29, v29
  v_exp_f32 v30, v30
  v_exp_f32 v31, v31
  s_setprio 2
  v_exp_f32 v32, v32
  v_exp_f32 v33, v33
  s_waitcnt lgkmcnt(2)
  v_smfmac_f32_32x32x32_bf16 v[48:63], v[92:95], v[24:31], v15
  ds_read_b128 v[92:95], v11 offset:21840
  buffer_load_ushort v140, v14, s[52:55], s62 offen offset:256
  v_exp_f32 v34, v34
  v_exp_f32 v35, v35
  v_exp_f32 v36, v36
  s_waitcnt lgkmcnt(2)
  v_mfma_f32_32x32x16_bf16 v[16:31], v[84:87], v[80:83], 0
  ds_read_b128 v[84:87], v13 offset:23552
  buffer_load_ushort v141, v14, s[52:55], s62 offen offset:288
  v_exp_f32 v37, v37
  v_exp_f32 v38, v38
  v_exp_f32 v39, v39
  v_exp_f32 v40, v40
  v_exp_f32 v41, v41
  s_waitcnt lgkmcnt(2)
  v_smfmac_f32_32x32x32_bf16 v[48:63], v[88:91], v[32:39], v15
  ds_read_b128 v[88:91], v10 offset:22880
  v_exp_f32 v42, v42
  v_exp_f32 v43, v43
  v_exp_f32 v44, v44
  v_exp_f32 v45, v45
  v_exp_f32 v46, v46
  v_exp_f32 v47, v47
  v_exp_f32 v16, v16
  v_exp_f32 v17, v17
  s_waitcnt lgkmcnt(2)
  v_smfmac_f32_32x32x32_bf16 v[48:63], v[92:95], v[40:47], v15
  ds_read_b128 v[92:95], v11 offset:22880
  buffer_load_ushort v142, v14, s[52:55], s62 offen offset:320
  v_exp_f32 v18, v18
  v_exp_f32 v19, v19
  v_exp_f32 v20, v20
  s_waitcnt lgkmcnt(2)
  v_mfma_f32_32x32x16_bf16 v[32:47], v[84:87], v[80:83], 0
  ds_read_b128 v[84:87], v13 offset:24576
  buffer_load_ushort v143, v14, s[52:55], s62 offen offset:352
  v_exp_f32 v21, v21
  v_exp_f32 v22, v22
  v_exp_f32 v23, v23
  v_exp_f32 v24, v24
  v_exp_f32 v25, v25
  s_waitcnt lgkmcnt(2)
  v_smfmac_f32_32x32x32_bf16 v[48:63], v[88:91], v[16:23], v15
  ds_read_b128 v[88:91], v10 offset:23920
  v_exp_f32 v26, v26
  v_exp_f32 v27, v27
  v_exp_f32 v28, v28
  v_exp_f32 v29, v29
  v_exp_f32 v30, v30
  v_exp_f32 v31, v31
  v_exp_f32 v32, v32
  v_exp_f32 v33, v33
  s_waitcnt lgkmcnt(2)
  v_smfmac_f32_32x32x32_bf16 v[48:63], v[92:95], v[24:31], v15
  ds_read_b128 v[92:95], v11 offset:23920
  v_exp_f32 v34, v34
  v_exp_f32 v35, v35
  v_exp_f32 v36, v36
  s_waitcnt lgkmcnt(2)
  v_mfma_f32_32x32x16_bf16 v[16:31], v[84:87], v[80:83], 0
  ds_read_b128 v[84:87], v13 offset:25600
  v_exp_f32 v37, v37
  v_exp_f32 v38, v38
  v_exp_f32 v39, v39
  v_exp_f32 v40, v40
  v_exp_f32 v41, v41
  s_waitcnt lgkmcnt(2)
  v_smfmac_f32_32x32x32_bf16 v[48:63], v[88:91], v[32:39], v15
  ds_read_b128 v[88:91], v10 offset:24960
  v_exp_f32 v42, v42
  v_exp_f32 v43, v43
  v_exp_f32 v44, v44
  v_exp_f32 v45, v45
  v_exp_f32 v46, v46
  v_exp_f32 v47, v47
  v_exp_f32 v16, v16
  v_exp_f32 v17, v17
  s_waitcnt lgkmcnt(2)
  v_smfmac_f32_32x32x32_bf16 v[48:63], v[92:95], v[40:47], v15
  ds_read_b128 v[92:95], v11 offset:24960
  v_exp_f32 v18, v18
  v_exp_f32 v19, v19
  v_exp_f32 v20, v20
  s_waitcnt lgkmcnt(2)
  v_mfma_f32_32x32x16_bf16 v[32:47], v[84:87], v[80:83], 0
  ds_read_b128 v[84:87], v13 offset:26624
  v_exp_f32 v21, v21
  v_exp_f32 v22, v22
  v_exp_f32 v23, v23
  v_exp_f32 v24, v24
  v_exp_f32 v25, v25
  s_waitcnt lgkmcnt(2)
  v_smfmac_f32_32x32x32_bf16 v[48:63], v[88:91], v[16:23], v15
  ds_read_b128 v[88:91], v10 offset:26000
  v_exp_f32 v26, v26
  v_exp_f32 v27, v27
  v_exp_f32 v28, v28
  v_exp_f32 v29, v29
  v_exp_f32 v30, v30
  v_exp_f32 v31, v31
  v_exp_f32 v32, v32
  v_exp_f32 v33, v33
  s_waitcnt lgkmcnt(2)
  v_smfmac_f32_32x32x32_bf16 v[48:63], v[92:95], v[24:31], v15
  ds_read_b128 v[92:95], v11 offset:26000
  v_exp_f32 v34, v34
  v_exp_f32 v35, v35
  v_exp_f32 v36, v36
  s_waitcnt lgkmcnt(2)
  v_mfma_f32_32x32x16_bf16 v[16:31], v[84:87], v[80:83], 0
  ds_read_b128 v[84:87], v13 offset:27648
  v_exp_f32 v37, v37
  v_exp_f32 v38, v38
  v_exp_f32 v39, v39
  v_exp_f32 v40, v40
  v_exp_f32 v41, v41
  s_waitcnt lgkmcnt(2)
  v_smfmac_f32_32x32x32_bf16 v[48:63], v[88:91], v[32:39], v15
  ds_read_b128 v[88:91], v10 offset:27040
  v_exp_f32 v42, v42
  v_exp_f32 v43, v43
  v_exp_f32 v44, v44
  v_exp_f32 v45, v45
  v_exp_f32 v46, v46
  v_exp_f32 v47, v47
  s_setprio 1
  v_exp_f32 v16, v16
  v_exp_f32 v17, v17
  s_waitcnt lgkmcnt(2)
  v_smfmac_f32_32x32x32_bf16 v[48:63], v[92:95], v[40:47], v15
  ds_read_b128 v[92:95], v11 offset:27040
  v_exp_f32 v18, v18
  v_exp_f32 v19, v19
  v_exp_f32 v20, v20
  s_waitcnt lgkmcnt(2)
  v_mfma_f32_32x32x16_bf16 v[32:47], v[84:87], v[80:83], 0
  ds_read_b128 v[84:87], v13 offset:28672
  v_exp_f32 v21, v21
  v_exp_f32 v22, v22
  v_exp_f32 v23, v23
  v_exp_f32 v24, v24
  v_exp_f32 v25, v25
  s_waitcnt lgkmcnt(2)
  v_smfmac_f32_32x32x32_bf16 v[48:63], v[88:91], v[16:23], v15
  ds_read_b128 v[88:91], v10 offset:28080
  v_exp_f32 v26, v26
  v_exp_f32 v27, v27
  v_exp_f32 v28, v28
  v_exp_f32 v29, v29
  v_exp_f32 v30, v30
  v_exp_f32 v31, v31
  v_exp_f32 v32, v32
  v_exp_f32 v33, v33
  s_waitcnt lgkmcnt(2)
  v_smfmac_f32_32x32x32_bf16 v[48:63], v[92:95], v[24:31], v15
  ds_read_b128 v[92:95], v11 offset:28080
  v_exp_f32 v34, v34
  v_exp_f32 v35, v35
  v_exp_f32 v36, v36
  s_waitcnt lgkmcnt(2)
  v_mfma_f32_32x32x16_bf16 v[16:31], v[84:87], v[80:83], 0
  ds_read_b128 v[84:87], v13 offset:29696
  v_exp_f32 v37, v37
  v_exp_f32 v38, v38
  v_exp_f32 v39, v39
  v_exp_f32 v40, v40
  v_exp_f32 v41, v41
  s_waitcnt lgkmcnt(2)
  v_smfmac_f32_32x32x32_bf16 v[48:63], v[88:91], v[32:39], v15
  ds_read_b128 v[88:91], v10 offset:29120
  v_exp_f32 v42, v42
  v_exp_f32 v43, v43
  v_exp_f32 v44, v44
  v_exp_f32 v45, v45
  v_exp_f32 v46, v46
  v_exp_f32 v47, v47
  s_waitcnt vmcnt(0)
  v_lshl_or_b32 v100, v137, 16, v136
  v_lshl_or_b32 v101, v139, 16, v138
  v_lshl_or_b32 v102, v141, 16, v140
  v_lshl_or_b32 v103, v143, 16, v142
  v_xor_b32 v100, v100, v9
  v_xor_b32 v101, v101, v9
  v_xor_b32 v102, v102, v9
  v_xor_b32 v103, v103, v9
  s_nop 1
  v_mfma_f32_32x32x16_bf16 v[136:151], v[100:103], v[96:99], 0
  v_pk_add_f32 v[104:105], v[104:105], v[120:121]
  v_pk_add_f32 v[106:107], v[106:107], v[122:123]
  v_pk_add_f32 v[108:109], v[108:109], v[124:125]
  v_pk_add_f32 v[110:111], v[110:111], v[126:127]
  v_pk_add_f32 v[112:113], v[112:113], v[128:129]
  v_pk_add_f32 v[114:115], v[114:115], v[130:131]
  v_pk_add_f32 v[116:117], v[116:117], v[132:133]
  v_pk_add_f32 v[118:119], v[118:119], v[134:135]
  v_pk_add_f32 v[104:105], v[104:105], v[112:113]
  v_pk_add_f32 v[106:107], v[106:107], v[114:115]
  v_pk_add_f32 v[108:109], v[108:109], v[116:117]
  v_pk_add_f32 v[110:111], v[110:111], v[118:119]
  v_pk_add_f32 v[104:105], v[104:105], v[108:109]
  v_pk_add_f32 v[106:107], v[106:107], v[110:111]
  v_pk_add_f32 v[104:105], v[104:105], v[106:107]
  v_cvt_pk_bf16_f32 v104, v104, v105
  s_lshl_b32 s27, s21, 2
  s_and_b32 s28, s27, 12
  s_lshr_b32 s27, s21, 2
  s_lshl_b32 s27, s27, 10
  s_add_u32 s27, s27, s28
  s_add_u32 s27, s27, 132096
  v_add_u32 v2, s27, v13
  ds_write_b32 v2, v104
  v_max3_f32 v152, v136, v137, v138
  v_max3_f32 v154, v139, v140, v141
  v_max3_f32 v153, v144, v145, v146
  v_max3_f32 v155, v147, v148, v149
  v_max3_f32 v152, v152, v142, v143
  v_max3_f32 v153, v153, v150, v151
  v_max_f32 v152, v152, v154
  v_max_f32 v153, v153, v155
  s_nop 1
  v_permlane32_swap_b32 v152, v153
  s_nop 1
  v_max_f32 v152, v152, v153
  v_mul_f32 v152, 0xbfb8aa3b, v152
  s_nop 0
  v_mov_b32 v154, v152
  s_nop 1
  v_permlane32_swap_b32 v152, v154
  s_nop 1
  v_pk_fma_f32 v[136:137], v[136:137], s[72:73], v[152:153] op_sel_hi:[1,1,0]
  v_pk_fma_f32 v[138:139], v[138:139], s[72:73], v[152:153] op_sel_hi:[1,1,0]
  v_pk_fma_f32 v[140:141], v[140:141], s[72:73], v[152:153] op_sel_hi:[1,1,0]
  v_pk_fma_f32 v[142:143], v[142:143], s[72:73], v[152:153] op_sel_hi:[1,1,0]
  v_pk_fma_f32 v[144:145], v[144:145], s[72:73], v[154:155] op_sel_hi:[1,1,0]
  v_pk_fma_f32 v[146:147], v[146:147], s[72:73], v[154:155] op_sel_hi:[1,1,0]
  v_pk_fma_f32 v[148:149], v[148:149], s[72:73], v[154:155] op_sel_hi:[1,1,0]
  v_pk_fma_f32 v[150:151], v[150:151], s[72:73], v[154:155] op_sel_hi:[1,1,0]
  v_exp_f32 v136, v136
  v_exp_f32 v137, v137
  v_exp_f32 v138, v138
  v_exp_f32 v139, v139
  v_exp_f32 v140, v140
  v_exp_f32 v141, v141
  v_exp_f32 v142, v142
  v_exp_f32 v143, v143
  v_exp_f32 v144, v144
  v_exp_f32 v145, v145
  v_exp_f32 v146, v146
  v_exp_f32 v147, v147
  v_exp_f32 v148, v148
  v_exp_f32 v149, v149
  v_exp_f32 v150, v150
  v_exp_f32 v151, v151
  v_pk_add_f32 v[152:153], v[136:137], v[138:139]
  v_pk_add_f32 v[154:155], v[144:145], v[146:147]
  v_pk_add_f32 v[152:153], v[152:153], v[140:141]
  v_pk_add_f32 v[154:155], v[154:155], v[148:149]
  v_pk_add_f32 v[152:153], v[152:153], v[142:143]
  v_pk_add_f32 v[154:155], v[154:155], v[150:151]
  v_add_f32 v152, v152, v153
  v_add_f32 v153, v154, v155
  s_nop 1
  v_permlane32_swap_b32 v152, v153
  s_nop 1
  v_add_f32 v152, v152, v153
  v_rcp_f32 v152, v152
  s_nop 0
  v_mov_b32 v154, v152
  s_nop 1
  v_permlane32_swap_b32 v152, v154
  s_nop 1
  v_pk_mul_f32 v[136:137], v[136:137], v[152:153] op_sel_hi:[1,0]
  v_pk_mul_f32 v[138:139], v[138:139], v[152:153] op_sel_hi:[1,0]
  v_pk_mul_f32 v[140:141], v[140:141], v[152:153] op_sel_hi:[1,0]
  v_pk_mul_f32 v[142:143], v[142:143], v[152:153] op_sel_hi:[1,0]
  v_pk_mul_f32 v[144:145], v[144:145], v[154:155] op_sel_hi:[1,0]
  v_pk_mul_f32 v[146:147], v[146:147], v[154:155] op_sel_hi:[1,0]
  v_pk_mul_f32 v[148:149], v[148:149], v[154:155] op_sel_hi:[1,0]
  v_pk_mul_f32 v[150:151], v[150:151], v[154:155] op_sel_hi:[1,0]
  v_cvt_pk_bf16_f32 v136, v136, v137
  v_cvt_pk_bf16_f32 v137, v138, v139
  v_cvt_pk_bf16_f32 v138, v140, v141
  v_cvt_pk_bf16_f32 v139, v142, v143
  v_cvt_pk_bf16_f32 v140, v144, v145
  v_cvt_pk_bf16_f32 v141, v146, v147
  v_cvt_pk_bf16_f32 v142, v148, v149
  v_cvt_pk_bf16_f32 v143, v150, v151
  s_waitcnt lgkmcnt(0)
  v_exp_f32 v16, v16
  v_exp_f32 v17, v17
  s_waitcnt lgkmcnt(2)
  v_smfmac_f32_32x32x32_bf16 v[48:63], v[92:95], v[40:47], v15
  ds_read_b128 v[92:95], v11 offset:29120
  v_exp_f32 v18, v18
  v_exp_f32 v19, v19
  v_exp_f32 v20, v20
  s_waitcnt lgkmcnt(2)
  v_mfma_f32_32x32x16_bf16 v[32:47], v[84:87], v[80:83], 0
  ds_read_b128 v[84:87], v13 offset:30720
  v_exp_f32 v21, v21
  v_exp_f32 v22, v22
  v_exp_f32 v23, v23
  v_exp_f32 v24, v24
  v_exp_f32 v25, v25
  s_waitcnt lgkmcnt(2)
  v_smfmac_f32_32x32x32_bf16 v[48:63], v[88:91], v[16:23], v15
  ds_read_b128 v[88:91], v10 offset:30160
  v_exp_f32 v26, v26
  v_exp_f32 v27, v27
  v_exp_f32 v28, v28
  v_exp_f32 v29, v29
  v_exp_f32 v30, v30
  v_exp_f32 v31, v31
  s_setprio 0
  v_exp_f32 v32, v32
  v_exp_f32 v33, v33
  s_waitcnt lgkmcnt(2)
  v_smfmac_f32_32x32x32_bf16 v[48:63], v[92:95], v[24:31], v15
  ds_read_b128 v[92:95], v11 offset:30160
  v_exp_f32 v34, v34
  v_exp_f32 v35, v35
  v_exp_f32 v36, v36
  s_waitcnt lgkmcnt(2)
  v_mfma_f32_32x32x16_bf16 v[16:31], v[84:87], v[80:83], 0
  ds_read_b128 v[84:87], v13 offset:31744
  v_exp_f32 v37, v37
  v_exp_f32 v38, v38
  v_exp_f32 v39, v39
  v_exp_f32 v40, v40
  v_exp_f32 v41, v41
  s_waitcnt lgkmcnt(2)
  v_smfmac_f32_32x32x32_bf16 v[48:63], v[88:91], v[32:39], v15
  ds_read_b128 v[88:91], v10 offset:31200
  v_exp_f32 v42, v42
  v_exp_f32 v43, v43
  v_exp_f32 v44, v44
  v_exp_f32 v45, v45
  v_exp_f32 v46, v46
  v_exp_f32 v47, v47
  s_setprio 3
  s_barrier
  v_add_u32 v2, 132096, v13
  ds_read_b128 v[156:159], v2
  ds_read_b128 v[160:163], v2 offset:1024
  s_waitcnt lgkmcnt(0)
  v_mfma_f32_32x32x16_bf16 v[104:119], v[156:159], v[136:139], 0
  v_mfma_f32_32x32x16_bf16 v[104:119], v[160:163], v[140:143], v[104:119]
  v_exp_f32 v16, v16
  v_exp_f32 v17, v17
  s_waitcnt lgkmcnt(2)
  v_smfmac_f32_32x32x32_bf16 v[48:63], v[92:95], v[40:47], v15
  ds_read_b128 v[92:95], v11 offset:31200
  v_exp_f32 v18, v18
  v_exp_f32 v19, v19
  v_exp_f32 v20, v20
  s_waitcnt lgkmcnt(2)
  v_mfma_f32_32x32x16_bf16 v[32:47], v[84:87], v[80:83], 0
  ds_read_b128 v[84:87], v13 offset:32768
  v_exp_f32 v21, v21
  v_exp_f32 v22, v22
  v_exp_f32 v23, v23
  v_exp_f32 v24, v24
  v_exp_f32 v25, v25
  s_waitcnt lgkmcnt(2)
  v_smfmac_f32_32x32x32_bf16 v[48:63], v[88:91], v[16:23], v15
  ds_read_b128 v[88:91], v10 offset:32240
  v_exp_f32 v26, v26
  v_exp_f32 v27, v27
  v_exp_f32 v28, v28
  v_exp_f32 v29, v29
  v_exp_f32 v30, v30
  v_exp_f32 v31, v31
  v_exp_f32 v32, v32
  v_exp_f32 v33, v33
  s_waitcnt lgkmcnt(2)
  v_smfmac_f32_32x32x32_bf16 v[48:63], v[92:95], v[24:31], v15
  ds_read_b128 v[92:95], v11 offset:32240
  v_exp_f32 v34, v34
  v_exp_f32 v35, v35
  v_exp_f32 v36, v36
  s_waitcnt lgkmcnt(2)
  v_mfma_f32_32x32x16_bf16 v[16:31], v[84:87], v[80:83], 0
  ds_read_b128 v[84:87], v13 offset:33792
  v_exp_f32 v37, v37
  v_exp_f32 v38, v38
  v_exp_f32 v39, v39
  v_exp_f32 v40, v40
  v_exp_f32 v41, v41
  s_waitcnt lgkmcnt(2)
  v_smfmac_f32_32x32x32_bf16 v[48:63], v[88:91], v[32:39], v15
  ds_read_b128 v[88:91], v10 offset:33280
  v_exp_f32 v42, v42
  v_exp_f32 v43, v43
  v_exp_f32 v44, v44
  v_exp_f32 v45, v45
  v_exp_f32 v46, v46
  v_exp_f32 v47, v47
  s_setprio 2
  v_add_f32 v112, 0x358637bd, v112
  v_rcp_f32 v112, v112
  s_add_u32 s27, s24, 10485760
  v_pk_mul_f32 v[104:105], v[104:105], v[112:113] op_sel_hi:[1,0]
  v_pk_mul_f32 v[106:107], v[106:107], v[112:113] op_sel_hi:[1,0]
  v_pk_mul_f32 v[108:109], v[108:109], v[112:113] op_sel_hi:[1,0]
  v_pk_mul_f32 v[110:111], v[110:111], v[112:113] op_sel_hi:[1,0]
  v_cvt_pk_bf16_f32 v104, v104, v105
  v_cvt_pk_bf16_f32 v105, v106, v107
  v_cvt_pk_bf16_f32 v106, v108, v109
  v_cvt_pk_bf16_f32 v107, v110, v111
  buffer_store_dwordx4 v[104:107], v13, s[56:59], s27 offen sc1
  v_mov_b32 v108, -1
  v_mov_b32 v109, -1
  v_mov_b32 v110, -1
  v_mov_b32 v111, -1
  s_add_u32 s27, s22, 8388608
  buffer_store_dwordx4 v[108:111], v13, s[56:59], s27 offen sc1
  v_exp_f32 v16, v16
  v_exp_f32 v17, v17
  s_waitcnt lgkmcnt(2)
  v_smfmac_f32_32x32x32_bf16 v[48:63], v[92:95], v[40:47], v15
  ds_read_b128 v[92:95], v11 offset:33280
  v_exp_f32 v18, v18
  v_exp_f32 v19, v19
  v_exp_f32 v20, v20
  s_waitcnt lgkmcnt(2)
  v_mfma_f32_32x32x16_bf16 v[32:47], v[84:87], v[80:83], 0
  ds_read_b128 v[84:87], v13 offset:34816
  v_exp_f32 v21, v21
  v_exp_f32 v22, v22
  v_exp_f32 v23, v23
  v_exp_f32 v24, v24
  v_exp_f32 v25, v25
  s_waitcnt lgkmcnt(2)
  v_smfmac_f32_32x32x32_bf16 v[48:63], v[88:91], v[16:23], v15
  ds_read_b128 v[88:91], v10 offset:34320
  v_exp_f32 v26, v26
  v_exp_f32 v27, v27
  v_exp_f32 v28, v28
  v_exp_f32 v29, v29
  v_exp_f32 v30, v30
  v_exp_f32 v31, v31
  v_exp_f32 v32, v32
  v_exp_f32 v33, v33
  s_waitcnt lgkmcnt(2)
  v_smfmac_f32_32x32x32_bf16 v[48:63], v[92:95], v[24:31], v15
  ds_read_b128 v[92:95], v11 offset:34320
  v_exp_f32 v34, v34
  v_exp_f32 v35, v35
  v_exp_f32 v36, v36
  s_waitcnt lgkmcnt(2)
  v_mfma_f32_32x32x16_bf16 v[16:31], v[84:87], v[80:83], 0
  ds_read_b128 v[84:87], v13 offset:35840
  v_exp_f32 v37, v37
  v_exp_f32 v38, v38
  v_exp_f32 v39, v39
  v_exp_f32 v40, v40
  v_exp_f32 v41, v41
  s_waitcnt lgkmcnt(2)
  v_smfmac_f32_32x32x32_bf16 v[48:63], v[88:91], v[32:39], v15
  ds_read_b128 v[88:91], v10 offset:35360
  v_exp_f32 v42, v42
  v_exp_f32 v43, v43
  v_exp_f32 v44, v44
  v_exp_f32 v45, v45
  v_exp_f32 v46, v46
  v_exp_f32 v47, v47
  s_setprio 1
  v_exp_f32 v16, v16
  v_exp_f32 v17, v17
  s_waitcnt lgkmcnt(2)
  v_smfmac_f32_32x32x32_bf16 v[48:63], v[92:95], v[40:47], v15
  ds_read_b128 v[92:95], v11 offset:35360
  v_exp_f32 v18, v18
  v_exp_f32 v19, v19
  v_exp_f32 v20, v20
  s_waitcnt lgkmcnt(2)
  v_mfma_f32_32x32x16_bf16 v[32:47], v[84:87], v[80:83], 0
  ds_read_b128 v[84:87], v13 offset:36864
  v_exp_f32 v21, v21
  v_exp_f32 v22, v22
  v_exp_f32 v23, v23
  v_exp_f32 v24, v24
  v_exp_f32 v25, v25
  s_waitcnt lgkmcnt(2)
  v_smfmac_f32_32x32x32_bf16 v[48:63], v[88:91], v[16:23], v15
  ds_read_b128 v[88:91], v10 offset:36400
  v_exp_f32 v26, v26
  v_exp_f32 v27, v27
  v_exp_f32 v28, v28
  v_exp_f32 v29, v29
  v_exp_f32 v30, v30
  v_exp_f32 v31, v31
  s_setprio 0
  v_exp_f32 v32, v32
  v_exp_f32 v33, v33
  s_waitcnt lgkmcnt(2)
  v_smfmac_f32_32x32x32_bf16 v[48:63], v[92:95], v[24:31], v15
  ds_read_b128 v[92:95], v11 offset:36400
  v_exp_f32 v34, v34
  v_exp_f32 v35, v35
  v_exp_f32 v36, v36
  s_waitcnt lgkmcnt(2)
  v_mfma_f32_32x32x16_bf16 v[16:31], v[84:87], v[80:83], 0
  ds_read_b128 v[84:87], v13 offset:37888
  v_exp_f32 v37, v37
  v_exp_f32 v38, v38
  v_exp_f32 v39, v39
  v_exp_f32 v40, v40
  v_exp_f32 v41, v41
  s_waitcnt lgkmcnt(2)
  v_smfmac_f32_32x32x32_bf16 v[48:63], v[88:91], v[32:39], v15
  ds_read_b128 v[88:91], v10 offset:37440
  v_exp_f32 v42, v42
  v_exp_f32 v43, v43
  v_exp_f32 v44, v44
  v_exp_f32 v45, v45
  v_exp_f32 v46, v46
  v_exp_f32 v47, v47
  s_setprio 3
  s_waitcnt vmcnt(0)
  s_barrier
  s_cmp_lg_u32 s21, 4
  s_cbranch_scc1 FL_B
  s_lshl_b32 s68, s75, 12
  s_lshl_b32 s69, s74, 2
  s_add_u32 s68, s68, s69
  s_add_u32 s68, s68, 7372800
  v_lshrrev_b32 v3, 5, v0
  v_lshlrev_b32 v3, 24, v3
  v_lshl_add_u32 v3, v0, 7, v3
  v_mov_b32 v2, s99
  buffer_store_dword v2, v3, s[56:59], s68 offen sc1
FL_B:
  s_cmp_lg_u32 s21, 4
  s_cbranch_scc1 FL_A
  s_lshl_b32 s68, s74, 10
  s_lshl_b32 s69, s75, 2
  s_add_u32 s68, s68, s69
  s_add_u32 s68, s68, 7340032
  v_lshrrev_b32 v3, 3, v0
  v_lshlrev_b32 v3, 24, v3
  v_lshl_add_u32 v3, v0, 7, v3
  v_mov_b32 v2, s99
  buffer_store_dword v2, v3, s[56:59], s68 offen sc1
FL_A:
  s_lshl_b32 s28, s74, 3
  s_add_u32 s28, s28, s75
  s_lshl_b32 s28, s28, 7
  s_add_u32 s28, s28, 7340032
  v_and_b32 v1, 7, v0
  v_add_u32 v2, 8192, v0
  v_cmp_gt_u32 vcc, 32, v0
  v_cndmask_b32 v1, v1, v2, vcc
  v_lshlrev_b32 v1, 2, v1
  s_lshl_b32 s29, s74, 1
  s_and_b32 s32, s21, 1
  s_add_u32 s33, s29, s32
  s_lshl_b32 s29, s33, 2
  s_lshr_b32 s32, s21, 1
  s_add_u32 s29, s29, s32
  s_lshl_b32 s29, s29, 13
  s_add_u32 s29, s29, 8388608
  v_exp_f32 v16, v16
  v_exp_f32 v17, v17
  s_waitcnt lgkmcnt(2)
  v_smfmac_f32_32x32x32_bf16 v[48:63], v[92:95], v[40:47], v15
  ds_read_b128 v[92:95], v11 offset:37440
  s_add_u32 m0, s25, 0
  s_add_u32 s65, s64, 0
  buffer_load_dwordx4 v4, s[44:47], s65 offen lds
  v_exp_f32 v18, v18
  v_exp_f32 v19, v19
  v_exp_f32 v20, v20
  s_waitcnt lgkmcnt(2)
  v_mfma_f32_32x32x16_bf16 v[32:47], v[84:87], v[80:83], 0
  ds_read_b128 v[84:87], v13 offset:38912
  v_exp_f32 v21, v21
  v_exp_f32 v22, v22
  v_exp_f32 v23, v23
  v_exp_f32 v24, v24
  v_exp_f32 v25, v25
  s_waitcnt lgkmcnt(2)
  v_smfmac_f32_32x32x32_bf16 v[48:63], v[88:91], v[16:23], v15
  ds_read_b128 v[88:91], v10 offset:38480
  v_exp_f32 v26, v26
  v_exp_f32 v27, v27
  v_exp_f32 v28, v28
  v_exp_f32 v29, v29
  v_exp_f32 v30, v30
  v_exp_f32 v31, v31
  v_exp_f32 v32, v32
  v_exp_f32 v33, v33
  s_waitcnt lgkmcnt(2)
  v_smfmac_f32_32x32x32_bf16 v[48:63], v[92:95], v[24:31], v15
  ds_read_b128 v[92:95], v11 offset:38480
  s_add_u32 m0, s25, 1024
  s_add_u32 s65, s64, 8192
  buffer_load_dwordx4 v4, s[44:47], s65 offen lds
  v_exp_f32 v34, v34
  v_exp_f32 v35, v35
  v_exp_f32 v36, v36
  s_waitcnt lgkmcnt(2)
  v_mfma_f32_32x32x16_bf16 v[16:31], v[84:87], v[80:83], 0
  ds_read_b128 v[84:87], v13 offset:39936
  v_exp_f32 v37, v37
  v_exp_f32 v38, v38
  v_exp_f32 v39, v39
  v_exp_f32 v40, v40
  v_exp_f32 v41, v41
  s_waitcnt lgkmcnt(2)
  v_smfmac_f32_32x32x32_bf16 v[48:63], v[88:91], v[32:39], v15
  ds_read_b128 v[88:91], v10 offset:39520
  v_exp_f32 v42, v42
  v_exp_f32 v43, v43
  v_exp_f32 v44, v44
  v_exp_f32 v45, v45
  v_exp_f32 v46, v46
  v_exp_f32 v47, v47
  v_exp_f32 v16, v16
  v_exp_f32 v17, v17
  s_waitcnt lgkmcnt(2)
  v_smfmac_f32_32x32x32_bf16 v[48:63], v[92:95], v[40:47], v15
  ds_read_b128 v[92:95], v11 offset:39520
  s_add_u32 m0, s25, 2048
  s_add_u32 s65, s64, 16384
  buffer_load_dwordx4 v4, s[44:47], s65 offen lds
  v_exp_f32 v18, v18
  v_exp_f32 v19, v19
  v_exp_f32 v20, v20
  s_waitcnt lgkmcnt(2)
  v_mfma_f32_32x32x16_bf16 v[32:47], v[84:87], v[80:83], 0
  ds_read_b128 v[84:87], v13 offset:40960
  v_exp_f32 v21, v21
  v_exp_f32 v22, v22
  v_exp_f32 v23, v23
  v_exp_f32 v24, v24
  v_exp_f32 v25, v25
  s_waitcnt lgkmcnt(2)
  v_smfmac_f32_32x32x32_bf16 v[48:63], v[88:91], v[16:23], v15
  ds_read_b128 v[88:91], v10 offset:40560
  v_exp_f32 v26, v26
  v_exp_f32 v27, v27
  v_exp_f32 v28, v28
  v_exp_f32 v29, v29
  v_exp_f32 v30, v30
  v_exp_f32 v31, v31
  v_exp_f32 v32, v32
  v_exp_f32 v33, v33
  s_waitcnt lgkmcnt(2)
  v_smfmac_f32_32x32x32_bf16 v[48:63], v[92:95], v[24:31], v15
  ds_read_b128 v[92:95], v11 offset:40560
  s_add_u32 m0, s25, 3072
  s_add_u32 s65, s64, 24576
  buffer_load_dwordx4 v4, s[44:47], s65 offen lds
  v_exp_f32 v34, v34
  v_exp_f32 v35, v35
  v_exp_f32 v36, v36
  s_waitcnt lgkmcnt(2)
  v_mfma_f32_32x32x16_bf16 v[16:31], v[84:87], v[80:83], 0
  ds_read_b128 v[84:87], v13 offset:41984
  v_exp_f32 v37, v37
  v_exp_f32 v38, v38
  v_exp_f32 v39, v39
  v_exp_f32 v40, v40
  v_exp_f32 v41, v41
  s_waitcnt lgkmcnt(2)
  v_smfmac_f32_32x32x32_bf16 v[48:63], v[88:91], v[32:39], v15
  ds_read_b128 v[88:91], v10 offset:41600
  v_exp_f32 v42, v42
  v_exp_f32 v43, v43
  v_exp_f32 v44, v44
  v_exp_f32 v45, v45
  v_exp_f32 v46, v46
  v_exp_f32 v47, v47
  v_exp_f32 v16, v16
  v_exp_f32 v17, v17
  s_waitcnt lgkmcnt(2)
  v_smfmac_f32_32x32x32_bf16 v[48:63], v[92:95], v[40:47], v15
  ds_read_b128 v[92:95], v11 offset:41600
  s_add_u32 m0, s25, 4096
  s_add_u32 s65, s64, 32768
  buffer_load_dwordx4 v4, s[44:47], s65 offen lds
  v_exp_f32 v18, v18
  v_exp_f32 v19, v19
  v_exp_f32 v20, v20
  s_waitcnt lgkmcnt(2)
  v_mfma_f32_32x32x16_bf16 v[32:47], v[84:87], v[80:83], 0
  ds_read_b128 v[84:87], v13 offset:43008
  v_exp_f32 v21, v21
  v_exp_f32 v22, v22
  v_exp_f32 v23, v23
  v_exp_f32 v24, v24
  v_exp_f32 v25, v25
  s_waitcnt lgkmcnt(2)
  v_smfmac_f32_32x32x32_bf16 v[48:63], v[88:91], v[16:23], v15
  ds_read_b128 v[88:91], v10 offset:42640
  v_exp_f32 v26, v26
  v_exp_f32 v27, v27
  v_exp_f32 v28, v28
  v_exp_f32 v29, v29
  v_exp_f32 v30, v30
  v_exp_f32 v31, v31
  v_exp_f32 v32, v32
  v_exp_f32 v33, v33
  s_waitcnt lgkmcnt(2)
  v_smfmac_f32_32x32x32_bf16 v[48:63], v[92:95], v[24:31], v15
  ds_read_b128 v[92:95], v11 offset:42640
  s_add_u32 m0, s25, 5120
  s_add_u32 s65, s64, 40960
  buffer_load_dwordx4 v4, s[44:47], s65 offen lds
  v_exp_f32 v34, v34
  v_exp_f32 v35, v35
  v_exp_f32 v36, v36
  s_waitcnt lgkmcnt(2)
  v_mfma_f32_32x32x16_bf16 v[16:31], v[84:87], v[80:83], 0
  ds_read_b128 v[84:87], v13 offset:44032
  v_exp_f32 v37, v37
  v_exp_f32 v38, v38
  v_exp_f32 v39, v39
  v_exp_f32 v40, v40
  v_exp_f32 v41, v41
  s_waitcnt lgkmcnt(2)
  v_smfmac_f32_32x32x32_bf16 v[48:63], v[88:91], v[32:39], v15
  ds_read_b128 v[88:91], v10 offset:43680
  v_exp_f32 v42, v42
  v_exp_f32 v43, v43
  v_exp_f32 v44, v44
  v_exp_f32 v45, v45
  v_exp_f32 v46, v46
  v_exp_f32 v47, v47
  v_exp_f32 v16, v16
  v_exp_f32 v17, v17
  s_waitcnt lgkmcnt(2)
  v_smfmac_f32_32x32x32_bf16 v[48:63], v[92:95], v[40:47], v15
  ds_read_b128 v[92:95], v11 offset:43680
  s_add_u32 m0, s25, 6144
  s_add_u32 s65, s64, 49152
  buffer_load_dwordx4 v4, s[44:47], s65 offen lds
  v_exp_f32 v18, v18
  v_exp_f32 v19, v19
  v_exp_f32 v20, v20
  s_waitcnt lgkmcnt(2)
  v_mfma_f32_32x32x16_bf16 v[32:47], v[84:87], v[80:83], 0
  ds_read_b128 v[84:87], v13 offset:45056
  v_exp_f32 v21, v21
  v_exp_f32 v22, v22
  v_exp_f32 v23, v23
  v_exp_f32 v24, v24
  v_exp_f32 v25, v25
  s_waitcnt lgkmcnt(2)
  v_smfmac_f32_32x32x32_bf16 v[48:63], v[88:91], v[16:23], v15
  ds_read_b128 v[88:91], v10 offset:44720
  v_exp_f32 v26, v26
  v_exp_f32 v27, v27
  v_exp_f32 v28, v28
  v_exp_f32 v29, v29
  v_exp_f32 v30, v30
  v_exp_f32 v31, v31
  v_exp_f32 v32, v32
  v_exp_f32 v33, v33
  s_waitcnt lgkmcnt(2)
  v_smfmac_f32_32x32x32_bf16 v[48:63], v[92:95], v[24:31], v15
  ds_read_b128 v[92:95], v11 offset:44720
  s_add_u32 m0, s25, 7168
  s_add_u32 s65, s64, 57344
  buffer_load_dwordx4 v4, s[44:47], s65 offen lds
  v_exp_f32 v34, v34
  v_exp_f32 v35, v35
  v_exp_f32 v36, v36
  s_waitcnt lgkmcnt(2)
  v_mfma_f32_32x32x16_bf16 v[16:31], v[84:87], v[80:83], 0
  ds_read_b128 v[84:87], v13 offset:46080
  v_exp_f32 v37, v37
  v_exp_f32 v38, v38
  v_exp_f32 v39, v39
  v_exp_f32 v40, v40
  v_exp_f32 v41, v41
  s_waitcnt lgkmcnt(2)
  v_smfmac_f32_32x32x32_bf16 v[48:63], v[88:91], v[32:39], v15
  ds_read_b128 v[88:91], v10 offset:45760
  v_exp_f32 v42, v42
  v_exp_f32 v43, v43
  v_exp_f32 v44, v44
  v_exp_f32 v45, v45
  v_exp_f32 v46, v46
  v_exp_f32 v47, v47
  buffer_load_dword v64, v1, s[56:59], s28 offen sc1
  v_exp_f32 v16, v16
  v_exp_f32 v17, v17
  s_waitcnt lgkmcnt(2)
  v_smfmac_f32_32x32x32_bf16 v[48:63], v[92:95], v[40:47], v15
  ds_read_b128 v[92:95], v11 offset:45760
  v_exp_f32 v18, v18
  v_exp_f32 v19, v19
  v_exp_f32 v20, v20
  s_waitcnt lgkmcnt(2)
  v_mfma_f32_32x32x16_bf16 v[32:47], v[84:87], v[80:83], 0
  ds_read_b128 v[84:87], v13 offset:47104
  v_exp_f32 v21, v21
  v_exp_f32 v22, v22
  v_exp_f32 v23, v23
  v_exp_f32 v24, v24
  v_exp_f32 v25, v25
  s_waitcnt lgkmcnt(2)
  v_smfmac_f32_32x32x32_bf16 v[48:63], v[88:91], v[16:23], v15
  ds_read_b128 v[88:91], v10 offset:46800
  v_exp_f32 v26, v26
  v_exp_f32 v27, v27
  v_exp_f32 v28, v28
  v_exp_f32 v29, v29
  v_exp_f32 v30, v30
  v_exp_f32 v31, v31
  v_exp_f32 v32, v32
  v_exp_f32 v33, v33
  s_waitcnt lgkmcnt(2)
  v_smfmac_f32_32x32x32_bf16 v[48:63], v[92:95], v[24:31], v15
  ds_read_b128 v[92:95], v11 offset:46800
  v_exp_f32 v34, v34
  v_exp_f32 v35, v35
  v_exp_f32 v36, v36
  s_waitcnt lgkmcnt(2)
  v_mfma_f32_32x32x16_bf16 v[16:31], v[84:87], v[80:83], 0
  ds_read_b128 v[84:87], v13 offset:48128
  v_exp_f32 v37, v37
  v_exp_f32 v38, v38
  v_exp_f32 v39, v39
  v_exp_f32 v40, v40
  v_exp_f32 v41, v41
  s_waitcnt lgkmcnt(2)
  v_smfmac_f32_32x32x32_bf16 v[48:63], v[88:91], v[32:39], v15
  ds_read_b128 v[88:91], v10 offset:47840
  v_exp_f32 v42, v42
  v_exp_f32 v43, v43
  v_exp_f32 v44, v44
  v_exp_f32 v45, v45
  v_exp_f32 v46, v46
  v_exp_f32 v47, v47
  v_exp_f32 v16, v16
  v_exp_f32 v17, v17
  s_waitcnt lgkmcnt(2)
  v_smfmac_f32_32x32x32_bf16 v[48:63], v[92:95], v[40:47], v15
  ds_read_b128 v[92:95], v11 offset:47840
  v_exp_f32 v18, v18
  v_exp_f32 v19, v19
  v_exp_f32 v20, v20
  s_waitcnt lgkmcnt(2)
  v_mfma_f32_32x32x16_bf16 v[32:47], v[84:87], v[80:83], 0
  ds_read_b128 v[84:87], v13 offset:49152
  v_exp_f32 v21, v21
  v_exp_f32 v22, v22
  v_exp_f32 v23, v23
  v_exp_f32 v24, v24
  v_exp_f32 v25, v25
  s_waitcnt lgkmcnt(2)
  v_smfmac_f32_32x32x32_bf16 v[48:63], v[88:91], v[16:23], v15
  ds_read_b128 v[88:91], v10 offset:48880
  v_exp_f32 v26, v26
  v_exp_f32 v27, v27
  v_exp_f32 v28, v28
  v_exp_f32 v29, v29
  v_exp_f32 v30, v30
  v_exp_f32 v31, v31
  v_exp_f32 v32, v32
  v_exp_f32 v33, v33
  s_waitcnt lgkmcnt(2)
  v_smfmac_f32_32x32x32_bf16 v[48:63], v[92:95], v[24:31], v15
  ds_read_b128 v[92:95], v11 offset:48880
  v_exp_f32 v34, v34
  v_exp_f32 v35, v35
  v_exp_f32 v36, v36
  s_waitcnt lgkmcnt(2)
  v_mfma_f32_32x32x16_bf16 v[16:31], v[84:87], v[80:83], 0
  ds_read_b128 v[84:87], v13 offset:50176
  v_exp_f32 v37, v37
  v_exp_f32 v38, v38
  v_exp_f32 v39, v39
  v_exp_f32 v40, v40
  v_exp_f32 v41, v41
  s_waitcnt lgkmcnt(2)
  v_smfmac_f32_32x32x32_bf16 v[48:63], v[88:91], v[32:39], v15
  ds_read_b128 v[88:91], v10 offset:49920
  v_exp_f32 v42, v42
  v_exp_f32 v43, v43
  v_exp_f32 v44, v44
  v_exp_f32 v45, v45
  v_exp_f32 v46, v46
  v_exp_f32 v47, v47
  v_exp_f32 v16, v16
  v_exp_f32 v17, v17
  s_waitcnt lgkmcnt(2)
  v_smfmac_f32_32x32x32_bf16 v[48:63], v[92:95], v[40:47], v15
  ds_read_b128 v[92:95], v11 offset:49920
  v_exp_f32 v18, v18
  v_exp_f32 v19, v19
  v_exp_f32 v20, v20
  s_waitcnt lgkmcnt(2)
  v_mfma_f32_32x32x16_bf16 v[32:47], v[84:87], v[80:83], 0
  ds_read_b128 v[84:87], v13 offset:51200
  v_exp_f32 v21, v21
  v_exp_f32 v22, v22
  v_exp_f32 v23, v23
  v_exp_f32 v24, v24
  v_exp_f32 v25, v25
  s_waitcnt lgkmcnt(2)
  v_smfmac_f32_32x32x32_bf16 v[48:63], v[88:91], v[16:23], v15
  ds_read_b128 v[88:91], v10 offset:50960
  v_exp_f32 v26, v26
  v_exp_f32 v27, v27
  v_exp_f32 v28, v28
  v_exp_f32 v29, v29
  v_exp_f32 v30, v30
  v_exp_f32 v31, v31
  s_waitcnt vmcnt(0)
SP_F:
  v_cmp_ne_u32 vcc, s99, v64
  s_cbranch_vccz SP_F_OK
  s_sleep 1
  buffer_load_dword v64, v1, s[56:59], s28 offen sc1
  s_add_u32 s97, s97, 1
  s_waitcnt vmcnt(0)
  s_cmp_lt_u32 s97, 0x40000
  s_cbranch_scc1 SP_F
SP_F_OK:
  v_exp_f32 v32, v32
  v_exp_f32 v33, v33
  s_waitcnt lgkmcnt(2)
  v_smfmac_f32_32x32x32_bf16 v[48:63], v[92:95], v[24:31], v15
  ds_read_b128 v[92:95], v11 offset:50960
  v_exp_f32 v34, v34
  v_exp_f32 v35, v35
  v_exp_f32 v36, v36
  s_waitcnt lgkmcnt(2)
  v_mfma_f32_32x32x16_bf16 v[16:31], v[84:87], v[80:83], 0
  ds_read_b128 v[84:87], v13 offset:52224
  v_exp_f32 v37, v37
  v_exp_f32 v38, v38
  v_exp_f32 v39, v39
  v_exp_f32 v40, v40
  v_exp_f32 v41, v41
  s_waitcnt lgkmcnt(2)
  v_smfmac_f32_32x32x32_bf16 v[48:63], v[88:91], v[32:39], v15
  ds_read_b128 v[88:91], v10 offset:52000
  v_exp_f32 v42, v42
  v_exp_f32 v43, v43
  v_exp_f32 v44, v44
  v_exp_f32 v45, v45
  v_exp_f32 v46, v46
  v_exp_f32 v47, v47
  s_setprio 2
  v_exp_f32 v16, v16
  v_exp_f32 v17, v17
  s_waitcnt lgkmcnt(2)
  v_smfmac_f32_32x32x32_bf16 v[48:63], v[92:95], v[40:47], v15
  ds_read_b128 v[92:95], v11 offset:52000
  s_add_u32 s27, s29, 2097152
  buffer_load_dwordx4 v[128:131], v13, s[56:59], s27 offen offset:0 sc1
  v_exp_f32 v18, v18
  v_exp_f32 v19, v19
  v_exp_f32 v20, v20
  s_waitcnt lgkmcnt(2)
  v_mfma_f32_32x32x16_bf16 v[32:47], v[84:87], v[80:83], 0
  ds_read_b128 v[84:87], v13 offset:53248
  v_exp_f32 v21, v21
  v_exp_f32 v22, v22
  v_exp_f32 v23, v23
  v_exp_f32 v24, v24
  v_exp_f32 v25, v25
  s_waitcnt lgkmcnt(2)
  v_smfmac_f32_32x32x32_bf16 v[48:63], v[88:91], v[16:23], v15
  ds_read_b128 v[88:91], v10 offset:53040
  v_exp_f32 v26, v26
  v_exp_f32 v27, v27
  v_exp_f32 v28, v28
  v_exp_f32 v29, v29
  v_exp_f32 v30, v30
  v_exp_f32 v31, v31
  v_exp_f32 v32, v32
  v_exp_f32 v33, v33
  s_waitcnt lgkmcnt(2)
  v_smfmac_f32_32x32x32_bf16 v[48:63], v[92:95], v[24:31], v15
  ds_read_b128 v[92:95], v11 offset:53040
  buffer_load_dwordx4 v[132:135], v13, s[56:59], s27 offen offset:1024 sc1
  v_exp_f32 v34, v34
  v_exp_f32 v35, v35
  v_exp_f32 v36, v36
  s_waitcnt lgkmcnt(2)
  v_mfma_f32_32x32x16_bf16 v[16:31], v[84:87], v[80:83], 0
  ds_read_b128 v[84:87], v13 offset:54272
  v_exp_f32 v37, v37
  v_exp_f32 v38, v38
  v_exp_f32 v39, v39
  v_exp_f32 v40, v40
  v_exp_f32 v41, v41
  s_waitcnt lgkmcnt(2)
  v_smfmac_f32_32x32x32_bf16 v[48:63], v[88:91], v[32:39], v15
  ds_read_b128 v[88:91], v10 offset:54080
  v_exp_f32 v42, v42
  v_exp_f32 v43, v43
  v_exp_f32 v44, v44
  v_exp_f32 v45, v45
  v_exp_f32 v46, v46
  v_exp_f32 v47, v47
  v_exp_f32 v16, v16
  v_exp_f32 v17, v17
  s_waitcnt lgkmcnt(2)
  v_smfmac_f32_32x32x32_bf16 v[48:63], v[92:95], v[40:47], v15
  ds_read_b128 v[92:95], v11 offset:54080
  buffer_load_dwordx4 v[136:139], v13, s[56:59], s27 offen offset:2048 sc1
  v_exp_f32 v18, v18
  v_exp_f32 v19, v19
  v_exp_f32 v20, v20
  s_waitcnt lgkmcnt(2)
  v_mfma_f32_32x32x16_bf16 v[32:47], v[84:87], v[80:83], 0
  ds_read_b128 v[84:87], v13 offset:55296
  v_exp_f32 v21, v21
  v_exp_f32 v22, v22
  v_exp_f32 v23, v23
  v_exp_f32 v24, v24
  v_exp_f32 v25, v25
  s_waitcnt lgkmcnt(2)
  v_smfmac_f32_32x32x32_bf16 v[48:63], v[88:91], v[16:23], v15
  ds_read_b128 v[88:91], v10 offset:55120
  v_exp_f32 v26, v26
  v_exp_f32 v27, v27
  v_exp_f32 v28, v28
  v_exp_f32 v29, v29
  v_exp_f32 v30, v30
  v_exp_f32 v31, v31
  v_exp_f32 v32, v32
  v_exp_f32 v33, v33
  s_waitcnt lgkmcnt(2)
  v_smfmac_f32_32x32x32_bf16 v[48:63], v[92:95], v[24:31], v15
  ds_read_b128 v[92:95], v11 offset:55120
  buffer_load_dwordx4 v[140:143], v13, s[56:59], s27 offen offset:3072 sc1
  v_exp_f32 v34, v34
  v_exp_f32 v35, v35
  v_exp_f32 v36, v36
  s_waitcnt lgkmcnt(2)
  v_mfma_f32_32x32x16_bf16 v[16:31], v[84:87], v[80:83], 0
  ds_read_b128 v[84:87], v13 offset:56320
  v_exp_f32 v37, v37
  v_exp_f32 v38, v38
  v_exp_f32 v39, v39
  v_exp_f32 v40, v40
  v_exp_f32 v41, v41
  s_waitcnt lgkmcnt(2)
  v_smfmac_f32_32x32x32_bf16 v[48:63], v[88:91], v[32:39], v15
  ds_read_b128 v[88:91], v10 offset:56160
  v_exp_f32 v42, v42
  v_exp_f32 v43, v43
  v_exp_f32 v44, v44
  v_exp_f32 v45, v45
  v_exp_f32 v46, v46
  v_exp_f32 v47, v47
  v_exp_f32 v16, v16
  v_exp_f32 v17, v17
  s_waitcnt lgkmcnt(2)
  v_smfmac_f32_32x32x32_bf16 v[48:63], v[92:95], v[40:47], v15
  ds_read_b128 v[92:95], v11 offset:56160
  s_add_u32 s27, s29, 2101248
  buffer_load_dwordx4 v[144:147], v13, s[56:59], s27 offen offset:0 sc1
  v_exp_f32 v18, v18
  v_exp_f32 v19, v19
  v_exp_f32 v20, v20
  s_waitcnt lgkmcnt(2)
  v_mfma_f32_32x32x16_bf16 v[32:47], v[84:87], v[80:83], 0
  ds_read_b128 v[84:87], v13 offset:57344
  v_exp_f32 v21, v21
  v_exp_f32 v22, v22
  v_exp_f32 v23, v23
  v_exp_f32 v24, v24
  v_exp_f32 v25, v25
  s_waitcnt lgkmcnt(2)
  v_smfmac_f32_32x32x32_bf16 v[48:63], v[88:91], v[16:23], v15
  ds_read_b128 v[88:91], v10 offset:57200
  v_exp_f32 v26, v26
  v_exp_f32 v27, v27
  v_exp_f32 v28, v28
  v_exp_f32 v29, v29
  v_exp_f32 v30, v30
  v_exp_f32 v31, v31
  v_exp_f32 v32, v32
  v_exp_f32 v33, v33
  s_waitcnt lgkmcnt(2)
  v_smfmac_f32_32x32x32_bf16 v[48:63], v[92:95], v[24:31], v15
  ds_read_b128 v[92:95], v11 offset:57200
  buffer_load_dwordx4 v[148:151], v13, s[56:59], s27 offen offset:1024 sc1
  v_exp_f32 v34, v34
  v_exp_f32 v35, v35
  v_exp_f32 v36, v36
  s_waitcnt lgkmcnt(2)
  v_mfma_f32_32x32x16_bf16 v[16:31], v[84:87], v[80:83], 0
  ds_read_b128 v[84:87], v13 offset:58368
  v_exp_f32 v37, v37
  v_exp_f32 v38, v38
  v_exp_f32 v39, v39
  v_exp_f32 v40, v40
  v_exp_f32 v41, v41
  s_waitcnt lgkmcnt(2)
  v_smfmac_f32_32x32x32_bf16 v[48:63], v[88:91], v[32:39], v15
  ds_read_b128 v[88:91], v10 offset:58240
  v_exp_f32 v42, v42
  v_exp_f32 v43, v43
  v_exp_f32 v44, v44
  v_exp_f32 v45, v45
  v_exp_f32 v46, v46
  v_exp_f32 v47, v47
  v_exp_f32 v16, v16
  v_exp_f32 v17, v17
  s_waitcnt lgkmcnt(2)
  v_smfmac_f32_32x32x32_bf16 v[48:63], v[92:95], v[40:47], v15
  ds_read_b128 v[92:95], v11 offset:58240
  buffer_load_dwordx4 v[152:155], v13, s[56:59], s27 offen offset:2048 sc1
  v_exp_f32 v18, v18
  v_exp_f32 v19, v19
  v_exp_f32 v20, v20
  s_waitcnt lgkmcnt(2)
  v_mfma_f32_32x32x16_bf16 v[32:47], v[84:87], v[80:83], 0
  ds_read_b128 v[84:87], v13 offset:59392
  v_exp_f32 v21, v21
  v_exp_f32 v22, v22
  v_exp_f32 v23, v23
  v_exp_f32 v24, v24
  v_exp_f32 v25, v25
  s_waitcnt lgkmcnt(2)
  v_smfmac_f32_32x32x32_bf16 v[48:63], v[88:91], v[16:23], v15
  ds_read_b128 v[88:91], v10 offset:59280
  v_exp_f32 v26, v26
  v_exp_f32 v27, v27
  v_exp_f32 v28, v28
  v_exp_f32 v29, v29
  v_exp_f32 v30, v30
  v_exp_f32 v31, v31
  v_exp_f32 v32, v32
  v_exp_f32 v33, v33
  s_waitcnt lgkmcnt(2)
  v_smfmac_f32_32x32x32_bf16 v[48:63], v[92:95], v[24:31], v15
  ds_read_b128 v[92:95], v11 offset:59280
  buffer_load_dwordx4 v[156:159], v13, s[56:59], s27 offen offset:3072 sc1
  v_exp_f32 v34, v34
  v_exp_f32 v35, v35
  v_exp_f32 v36, v36
  s_waitcnt lgkmcnt(2)
  v_mfma_f32_32x32x16_bf16 v[16:31], v[84:87], v[80:83], 0
  ds_read_b128 v[84:87], v13 offset:60416
  v_exp_f32 v37, v37
  v_exp_f32 v38, v38
  v_exp_f32 v39, v39
  v_exp_f32 v40, v40
  v_exp_f32 v41, v41
  s_waitcnt lgkmcnt(2)
  v_smfmac_f32_32x32x32_bf16 v[48:63], v[88:91], v[32:39], v15
  ds_read_b128 v[88:91], v10 offset:60320
  v_exp_f32 v42, v42
  v_exp_f32 v43, v43
  v_exp_f32 v44, v44
  v_exp_f32 v45, v45
  v_exp_f32 v46, v46
  v_exp_f32 v47, v47
  s_setprio 1
  v_exp_f32 v16, v16
  v_exp_f32 v17, v17
  s_waitcnt lgkmcnt(2)
  v_smfmac_f32_32x32x32_bf16 v[48:63], v[92:95], v[40:47], v15
  ds_read_b128 v[92:95], v11 offset:60320
  v_exp_f32 v18, v18
  v_exp_f32 v19, v19
  v_exp_f32 v20, v20
  s_waitcnt lgkmcnt(2)
  v_mfma_f32_32x32x16_bf16 v[32:47], v[84:87], v[80:83], 0
  ds_read_b128 v[84:87], v13 offset:61440
  v_exp_f32 v21, v21
  v_exp_f32 v22, v22
  v_exp_f32 v23, v23
  v_exp_f32 v24, v24
  v_exp_f32 v25, v25
  s_waitcnt lgkmcnt(2)
  v_smfmac_f32_32x32x32_bf16 v[48:63], v[88:91], v[16:23], v15
  ds_read_b128 v[88:91], v10 offset:61360
  v_exp_f32 v26, v26
  v_exp_f32 v27, v27
  v_exp_f32 v28, v28
  v_exp_f32 v29, v29
  v_exp_f32 v30, v30
  v_exp_f32 v31, v31
  v_exp_f32 v32, v32
  v_exp_f32 v33, v33
  s_waitcnt lgkmcnt(2)
  v_smfmac_f32_32x32x32_bf16 v[48:63], v[92:95], v[24:31], v15
  ds_read_b128 v[92:95], v11 offset:61360
  v_exp_f32 v34, v34
  v_exp_f32 v35, v35
  v_exp_f32 v36, v36
  s_waitcnt lgkmcnt(2)
  v_mfma_f32_32x32x16_bf16 v[16:31], v[84:87], v[80:83], 0
  ds_read_b128 v[84:87], v13 offset:62464
  v_exp_f32 v37, v37
  v_exp_f32 v38, v38
  v_exp_f32 v39, v39
  v_exp_f32 v40, v40
  v_exp_f32 v41, v41
  s_waitcnt lgkmcnt(2)
  v_smfmac_f32_32x32x32_bf16 v[48:63], v[88:91], v[32:39], v15
  ds_read_b128 v[88:91], v10 offset:62400
  v_exp_f32 v42, v42
  v_exp_f32 v43, v43
  v_exp_f32 v44, v44
  v_exp_f32 v45, v45
  v_exp_f32 v46, v46
  v_exp_f32 v47, v47
  v_exp_f32 v16, v16
  v_exp_f32 v17, v17
  s_waitcnt lgkmcnt(2)
  v_smfmac_f32_32x32x32_bf16 v[48:63], v[92:95], v[40:47], v15
  ds_read_b128 v[92:95], v11 offset:62400
  v_exp_f32 v18, v18
  v_exp_f32 v19, v19
  v_exp_f32 v20, v20
  s_waitcnt lgkmcnt(2)
  v_mfma_f32_32x32x16_bf16 v[32:47], v[84:87], v[80:83], 0
  ds_read_b128 v[84:87], v13 offset:63488
  v_exp_f32 v21, v21
  v_exp_f32 v22, v22
  v_exp_f32 v23, v23
  v_exp_f32 v24, v24
  v_exp_f32 v25, v25
  s_waitcnt lgkmcnt(2)
  v_smfmac_f32_32x32x32_bf16 v[48:63], v[88:91], v[16:23], v15
  ds_read_b128 v[88:91], v10 offset:63440
  v_exp_f32 v26, v26
  v_exp_f32 v27, v27
  v_exp_f32 v28, v28
  v_exp_f32 v29, v29
  v_exp_f32 v30, v30
  v_exp_f32 v31, v31
  v_exp_f32 v32, v32
  v_exp_f32 v33, v33
  s_waitcnt lgkmcnt(2)
  v_smfmac_f32_32x32x32_bf16 v[48:63], v[92:95], v[24:31], v15
  ds_read_b128 v[92:95], v11 offset:63440
  v_exp_f32 v34, v34
  v_exp_f32 v35, v35
  v_exp_f32 v36, v36
  s_waitcnt lgkmcnt(2)
  v_mfma_f32_32x32x16_bf16 v[16:31], v[84:87], v[80:83], 0
  ds_read_b128 v[84:87], v13 offset:64512
  v_exp_f32 v37, v37
  v_exp_f32 v38, v38
  v_exp_f32 v39, v39
  v_exp_f32 v40, v40
  v_exp_f32 v41, v41
  s_waitcnt lgkmcnt(2)
  v_smfmac_f32_32x32x32_bf16 v[48:63], v[88:91], v[32:39], v15
  ds_read_b128 v[88:91], v10 offset:64480
  v_exp_f32 v42, v42
  v_exp_f32 v43, v43
  v_exp_f32 v44, v44
  v_exp_f32 v45, v45
  v_exp_f32 v46, v46
  v_exp_f32 v47, v47
  s_setprio 0
  v_exp_f32 v16, v16
  v_exp_f32 v17, v17
  s_waitcnt lgkmcnt(2)
  v_smfmac_f32_32x32x32_bf16 v[48:63], v[92:95], v[40:47], v15
  ds_read_b128 v[92:95], v11 offset:64480
  v_exp_f32 v18, v18
  v_exp_f32 v19, v19
  v_exp_f32 v20, v20
  s_waitcnt lgkmcnt(2)
  v_mfma_f32_32x32x16_bf16 v[32:47], v[84:87], v[80:83], 0
  v_exp_f32 v21, v21
  v_exp_f32 v22, v22
  v_exp_f32 v23, v23
  v_exp_f32 v24, v24
  v_exp_f32 v25, v25
  s_waitcnt lgkmcnt(1)
  v_smfmac_f32_32x32x32_bf16 v[48:63], v[88:91], v[16:23], v15
  ds_read_b128 v[88:91], v10 offset:65520
  v_exp_f32 v26, v26
  v_exp_f32 v27, v27
  v_exp_f32 v28, v28
  v_exp_f32 v29, v29
  v_exp_f32 v30, v30
  v_exp_f32 v31, v31
  v_exp_f32 v32, v32
  v_exp_f32 v33, v33
  s_waitcnt lgkmcnt(1)
  v_smfmac_f32_32x32x32_bf16 v[48:63], v[92:95], v[24:31], v15
  ds_read_b128 v[92:95], v11 offset:65520
  v_exp_f32 v34, v34
  v_exp_f32 v35, v35
  v_exp_f32 v36, v36
  v_exp_f32 v37, v37
  v_exp_f32 v38, v38
  v_exp_f32 v39, v39
  v_exp_f32 v40, v40
  v_exp_f32 v41, v41
  s_waitcnt lgkmcnt(1)
  v_smfmac_f32_32x32x32_bf16 v[48:63], v[88:91], v[32:39], v15
  v_exp_f32 v42, v42
  v_exp_f32 v43, v43
  v_exp_f32 v44, v44
  v_exp_f32 v45, v45
  v_exp_f32 v46, v46
  v_exp_f32 v47, v47
  s_waitcnt lgkmcnt(0)
  s_nop 0
  v_smfmac_f32_32x32x32_bf16 v[48:63], v[92:95], v[40:47], v15
  v_lshrrev_b32 v3, 5, v0
  v_bfe_u32 v4, v0, 2, 2
  v_lshl_add_u32 v5, v3, 2, v4
  v_bfe_u32 v7, v0, 1, 1
  v_lshl_add_u32 v7, v6, 1, v7
  s_bfe_u32 s34, s21, 0x10001
  v_bfe_u32 v8, v0, 3, 1
  s_lshl_b32 s34, s34, 14
  s_add_u32 s31, s31, s34
  v_lshl_add_u32 v7, v8, 2, v7
  v_lshlrev_b32 v7, 4, v7
  v_and_b32 v8, 1, v0
  v_lshl_add_u32 v7, v8, 3, v7
  v_lshl_add_u32 v7, v5, 7, v7
  v_mov_b32 v2, 0x1f800000
  v_mov_b32 v4, 0x5f800000
  v_cmp_nge_f32 vcc, v56, v2
  v_cmp_nle_f32 s[36:37], v56, v4
  s_or_b64 vcc, vcc, s[36:37]
  s_cbranch_vccnz K2_MAX
K2_FIN:
  v_rcp_f32 v56, v56
  s_add_u32 s27, s22, 8388608
  v_pk_mul_f32 v[48:49], v[48:49], v[56:57] op_sel_hi:[1,0]
  v_pk_mul_f32 v[50:51], v[50:51], v[56:57] op_sel_hi:[1,0]
  v_pk_mul_f32 v[52:53], v[52:53], v[56:57] op_sel_hi:[1,0]
  v_pk_mul_f32 v[54:55], v[54:55], v[56:57] op_sel_hi:[1,0]
  v_cvt_pk_bf16_f32 v48, v48, v49
  v_cvt_pk_bf16_f32 v49, v50, v51
  v_cvt_pk_bf16_f32 v50, v52, v53
  v_cvt_pk_bf16_f32 v51, v54, v55
  buffer_store_dwordx4 v[48:51], v13, s[56:59], s27 offen sc1
  v_add_u32 v24, s31, v7
  v_xor_b32 v25, 64, v24
  s_add_u32 s25, s25, s26
  v_add_u32 v26, s25, v13
  s_and_b32 s34, s21, 1
  s_lshl_b32 s34, s34, 16
  s_lshl_b32 s35, s32, 11
  s_add_u32 s35, s35, s34
  v_add_u32 v27, s35, v13
  s_lshl_b32 s35, s32, 13
  s_add_u32 s35, s35, s34
  v_add_u32 v28, s35, v13
  v_and_b32 v2, 31, v0
  v_lshlrev_b32 v2, 11, v2
  v_lshl_add_u32 v14, v3, 4, v2
  s_lshl_b32 s63, s33, 16
  s_lshl_b32 s35, s75, 7
  s_add_u32 s63, s63, s35
  s_lshl_b32 s35, s32, 5
  s_add_u32 s63, s63, s35
  s_waitcnt vmcnt(1)
  s_barrier
  ds_write_b128 v26, v[192:195] offset:0
  ds_write_b128 v26, v[196:199] offset:1024
  ds_write_b128 v26, v[200:203] offset:2048
  ds_write_b128 v26, v[204:207] offset:3072
  ds_write_b128 v26, v[208:211] offset:4096
  ds_write_b128 v26, v[212:215] offset:5120
  ds_write_b128 v26, v[216:219] offset:6144
  ds_write_b128 v26, v[220:223] offset:7168
  ds_read_b64_tr_b16 v[68:69], v24 offset:0
  ds_read_b64_tr_b16 v[70:71], v24 offset:1024
  ds_read_b64_tr_b16 v[72:73], v25 offset:0
  ds_read_b64_tr_b16 v[74:75], v25 offset:1024
  ds_read_b64_tr_b16 v[76:77], v24 offset:2048
  ds_read_b64_tr_b16 v[78:79], v24 offset:3072
  s_waitcnt lgkmcnt(4)
  v_mfma_f32_32x32x16_bf16 v[32:47], v[68:71], v[128:131], 0
  ds_read_b64_tr_b16 v[68:69], v25 offset:2048
  ds_read_b64_tr_b16 v[70:71], v25 offset:3072
  s_waitcnt lgkmcnt(4)
  v_mfma_f32_32x32x16_bf16 v[48:63], v[72:75], v[128:131], 0
  ds_read_b64_tr_b16 v[72:73], v24 offset:4096
  ds_read_b64_tr_b16 v[74:75], v24 offset:5120
  s_waitcnt lgkmcnt(4)
  v_mfma_f32_32x32x16_bf16 v[32:47], v[76:79], v[132:135], v[32:47]
  ds_read_b64_tr_b16 v[76:77], v25 offset:4096
  ds_read_b64_tr_b16 v[78:79], v25 offset:5120
  s_waitcnt lgkmcnt(4)
  v_mfma_f32_32x32x16_bf16 v[48:63], v[68:71], v[132:135], v[48:63]
  ds_read_b64_tr_b16 v[68:69], v24 offset:6144
  ds_read_b64_tr_b16 v[70:71], v24 offset:7168
  s_waitcnt lgkmcnt(4)
  v_mfma_f32_32x32x16_bf16 v[32:47], v[72:75], v[136:139], v[32:47]
  ds_read_b64_tr_b16 v[72:73], v25 offset:6144
  ds_read_b64_tr_b16 v[74:75], v25 offset:7168
  s_waitcnt lgkmcnt(4)
  v_mfma_f32_32x32x16_bf16 v[48:63], v[76:79], v[136:139], v[48:63]
  ds_read_b64_tr_b16 v[76:77], v24 offset:8192
  ds_read_b64_tr_b16 v[78:79], v24 offset:9216
  s_add_u32 s27, s29, 0
  buffer_load_dwordx4 v[160:163], v13, s[56:59], s27 offen offset:0 sc1
  buffer_load_dwordx4 v[164:167], v13, s[56:59], s27 offen offset:1024 sc1
  buffer_load_dwordx4 v[168:171], v13, s[56:59], s27 offen offset:2048 sc1
  buffer_load_dwordx4 v[172:175], v13, s[56:59], s27 offen offset:3072 sc1
  s_add_u32 s27, s29, 4096
  buffer_load_dwordx4 v[176:179], v13, s[56:59], s27 offen offset:0 sc1
  buffer_load_dwordx4 v[180:183], v13, s[56:59], s27 offen offset:1024 sc1
  buffer_load_dwordx4 v[184:187], v13, s[56:59], s27 offen offset:2048 sc1
  buffer_load_dwordx4 v[188:191], v13, s[56:59], s27 offen offset:3072 sc1
  s_waitcnt lgkmcnt(4)
  v_mfma_f32_32x32x16_bf16 v[32:47], v[68:71], v[140:143], v[32:47]
  ds_read_b64_tr_b16 v[68:69], v25 offset:8192
  ds_read_b64_tr_b16 v[70:71], v25 offset:9216
  s_waitcnt lgkmcnt(4)
  v_mfma_f32_32x32x16_bf16 v[48:63], v[72:75], v[140:143], v[48:63]
  ds_read_b64_tr_b16 v[72:73], v24 offset:10240
  ds_read_b64_tr_b16 v[74:75], v24 offset:11264
  s_waitcnt lgkmcnt(4)
  v_mfma_f32_32x32x16_bf16 v[32:47], v[76:79], v[144:147], v[32:47]
  ds_read_b64_tr_b16 v[76:77], v25 offset:10240
  ds_read_b64_tr_b16 v[78:79], v25 offset:11264
  s_waitcnt lgkmcnt(4)
  v_mfma_f32_32x32x16_bf16 v[48:63], v[68:71], v[144:147], v[48:63]
  ds_read_b64_tr_b16 v[68:69], v24 offset:12288
  ds_read_b64_tr_b16 v[70:71], v24 offset:13312
  s_waitcnt lgkmcnt(4)
  v_mfma_f32_32x32x16_bf16 v[32:47], v[72:75], v[148:151], v[32:47]
  ds_read_b64_tr_b16 v[72:73], v25 offset:12288
  ds_read_b64_tr_b16 v[74:75], v25 offset:13312
  s_waitcnt lgkmcnt(4)
  v_mfma_f32_32x32x16_bf16 v[48:63], v[76:79], v[148:151], v[48:63]
  ds_read_b64_tr_b16 v[76:77], v24 offset:14336
  ds_read_b64_tr_b16 v[78:79], v24 offset:15360
  s_waitcnt lgkmcnt(4)
  v_mfma_f32_32x32x16_bf16 v[32:47], v[68:71], v[152:155], v[32:47]
  ds_read_b64_tr_b16 v[68:69], v25 offset:14336
  ds_read_b64_tr_b16 v[70:71], v25 offset:15360
  s_waitcnt lgkmcnt(4)
  v_mfma_f32_32x32x16_bf16 v[48:63], v[72:75], v[152:155], v[48:63]
  s_waitcnt lgkmcnt(2)
  v_mfma_f32_32x32x16_bf16 v[32:47], v[76:79], v[156:159], v[32:47]
  s_waitcnt lgkmcnt(0)
  v_mfma_f32_32x32x16_bf16 v[48:63], v[68:71], v[156:159], v[48:63]
  v_add_u32 v24, s26, v24
  v_add_u32 v25, s26, v25
  s_nop 7
  s_nop 1
  v_cvt_pk_bf16_f32 v96, v32, v33
  v_cvt_pk_bf16_f32 v97, v34, v35
  v_cvt_pk_bf16_f32 v98, v36, v37
  v_cvt_pk_bf16_f32 v99, v38, v39
  v_cvt_pk_bf16_f32 v100, v40, v41
  v_cvt_pk_bf16_f32 v101, v42, v43
  v_cvt_pk_bf16_f32 v102, v44, v45
  v_cvt_pk_bf16_f32 v103, v46, v47
  v_cvt_pk_bf16_f32 v104, v48, v49
  v_cvt_pk_bf16_f32 v105, v50, v51
  v_cvt_pk_bf16_f32 v106, v52, v53
  v_cvt_pk_bf16_f32 v107, v54, v55
  v_cvt_pk_bf16_f32 v108, v56, v57
  v_cvt_pk_bf16_f32 v109, v58, v59
  v_cvt_pk_bf16_f32 v110, v60, v61
  v_cvt_pk_bf16_f32 v111, v62, v63
  s_barrier
  ds_write_b128 v27, v[96:99] offset:0
  ds_write_b128 v27, v[100:103] offset:8192
  ds_write_b128 v27, v[104:107] offset:16384
  ds_write_b128 v27, v[108:111] offset:24576
  ds_read_b64_tr_b16 v[68:69], v24 offset:0
  ds_read_b64_tr_b16 v[70:71], v24 offset:1024
  ds_read_b64_tr_b16 v[72:73], v25 offset:0
  ds_read_b64_tr_b16 v[74:75], v25 offset:1024
  ds_read_b64_tr_b16 v[76:77], v24 offset:2048
  ds_read_b64_tr_b16 v[78:79], v24 offset:3072
  s_waitcnt lgkmcnt(4) vmcnt(7)
OC0:
  v_max3_u32 v2, v160, v161, v162
  v_max_u32 v2, v2, v163
  v_cmp_eq_u32 vcc, -1, v2
  s_cbranch_vccnz OR0
OK0:
  v_mfma_f32_32x32x16_bf16 v[32:47], v[68:71], v[160:163], 0
  ds_read_b64_tr_b16 v[68:69], v25 offset:2048
  ds_read_b64_tr_b16 v[70:71], v25 offset:3072
  s_waitcnt lgkmcnt(4)
  v_mfma_f32_32x32x16_bf16 v[48:63], v[72:75], v[160:163], 0
  ds_read_b64_tr_b16 v[72:73], v24 offset:4096
  ds_read_b64_tr_b16 v[74:75], v24 offset:5120
  s_waitcnt lgkmcnt(4) vmcnt(6)
OC2:
  v_max3_u32 v2, v164, v165, v166
  v_max_u32 v2, v2, v167
  v_cmp_eq_u32 vcc, -1, v2
  s_cbranch_vccnz OR2
OK2:
  v_mfma_f32_32x32x16_bf16 v[32:47], v[76:79], v[164:167], v[32:47]
  ds_read_b64_tr_b16 v[76:77], v25 offset:4096
  ds_read_b64_tr_b16 v[78:79], v25 offset:5120
  s_waitcnt lgkmcnt(4)
  v_mfma_f32_32x32x16_bf16 v[48:63], v[68:71], v[164:167], v[48:63]
  ds_read_b64_tr_b16 v[68:69], v24 offset:6144
  ds_read_b64_tr_b16 v[70:71], v24 offset:7168
  s_waitcnt lgkmcnt(4) vmcnt(5)
OC4:
  v_max3_u32 v2, v168, v169, v170
  v_max_u32 v2, v2, v171
  v_cmp_eq_u32 vcc, -1, v2
  s_cbranch_vccnz OR4
OK4:
  v_mfma_f32_32x32x16_bf16 v[32:47], v[72:75], v[168:171], v[32:47]
  ds_read_b64_tr_b16 v[72:73], v25 offset:6144
  ds_read_b64_tr_b16 v[74:75], v25 offset:7168
  s_waitcnt lgkmcnt(4)
  v_mfma_f32_32x32x16_bf16 v[48:63], v[76:79], v[168:171], v[48:63]
  ds_read_b64_tr_b16 v[76:77], v24 offset:8192
  ds_read_b64_tr_b16 v[78:79], v24 offset:9216
  s_barrier
  ds_read_b128 v[128:131], v28 offset:0
  ds_read_b128 v[132:135], v28 offset:2048
  ds_read_b128 v[136:139], v28 offset:4096
  ds_read_b128 v[140:143], v28 offset:6144
  s_waitcnt lgkmcnt(3)
  v_lshlrev_b32 v96, 16, v128
  v_and_b32 v97, 0xffff0000, v128
  v_lshlrev_b32 v98, 16, v129
  v_and_b32 v99, 0xffff0000, v129
  v_lshlrev_b32 v100, 16, v130
  v_and_b32 v101, 0xffff0000, v130
  v_lshlrev_b32 v102, 16, v131
  v_and_b32 v103, 0xffff0000, v131
  s_waitcnt lgkmcnt(2)
  v_lshlrev_b32 v104, 16, v132
  v_and_b32 v105, 0xffff0000, v132
  v_lshlrev_b32 v106, 16, v133
  v_and_b32 v107, 0xffff0000, v133
  v_lshlrev_b32 v108, 16, v134
  v_and_b32 v109, 0xffff0000, v134
  v_lshlrev_b32 v110, 16, v135
  v_and_b32 v111, 0xffff0000, v135
  v_pk_add_f32 v[96:97], v[96:97], v[104:105]
  v_pk_add_f32 v[98:99], v[98:99], v[106:107]
  v_pk_add_f32 v[100:101], v[100:101], v[108:109]
  v_pk_add_f32 v[102:103], v[102:103], v[110:111]
  s_waitcnt lgkmcnt(1)
  v_lshlrev_b32 v112, 16, v136
  v_and_b32 v113, 0xffff0000, v136
  v_lshlrev_b32 v114, 16, v137
  v_and_b32 v115, 0xffff0000, v137
  v_lshlrev_b32 v116, 16, v138
  v_and_b32 v117, 0xffff0000, v138
  v_lshlrev_b32 v118, 16, v139
  v_and_b32 v119, 0xffff0000, v139
  v_pk_add_f32 v[96:97], v[96:97], v[112:113]
  v_pk_add_f32 v[98:99], v[98:99], v[114:115]
  v_pk_add_f32 v[100:101], v[100:101], v[116:117]
  v_pk_add_f32 v[102:103], v[102:103], v[118:119]
  s_waitcnt lgkmcnt(0)
  v_lshlrev_b32 v120, 16, v140
  v_and_b32 v121, 0xffff0000, v140
  v_lshlrev_b32 v122, 16, v141
  v_and_b32 v123, 0xffff0000, v141
  v_lshlrev_b32 v124, 16, v142
  v_and_b32 v125, 0xffff0000, v142
  v_lshlrev_b32 v126, 16, v143
  v_and_b32 v127, 0xffff0000, v143
  v_pk_add_f32 v[96:97], v[96:97], v[120:121]
  v_pk_add_f32 v[98:99], v[98:99], v[122:123]
  v_pk_add_f32 v[100:101], v[100:101], v[124:125]
  v_pk_add_f32 v[102:103], v[102:103], v[126:127]
  v_cvt_pk_bf16_f32 v20, v96, v97
  v_cvt_pk_bf16_f32 v21, v98, v99
  v_cvt_pk_bf16_f32 v22, v100, v101
  v_cvt_pk_bf16_f32 v23, v102, v103
  s_nop 1
  v_permlane32_swap_b32 v20, v22
  v_permlane32_swap_b32 v21, v23
  buffer_store_dwordx4 v[20:23], v14, s[48:51], s63 offen offset:1024 nt
  s_waitcnt lgkmcnt(4) vmcnt(4)
OC6:
  v_max3_u32 v2, v172, v173, v174
  v_max_u32 v2, v2, v175
  v_cmp_eq_u32 vcc, -1, v2
  s_cbranch_vccnz OR6
OK6:
  v_mfma_f32_32x32x16_bf16 v[32:47], v[68:71], v[172:175], v[32:47]
  ds_read_b64_tr_b16 v[68:69], v25 offset:8192
  ds_read_b64_tr_b16 v[70:71], v25 offset:9216
  s_waitcnt lgkmcnt(4)
  v_mfma_f32_32x32x16_bf16 v[48:63], v[72:75], v[172:175], v[48:63]
  ds_read_b64_tr_b16 v[72:73], v24 offset:10240
  ds_read_b64_tr_b16 v[74:75], v24 offset:11264
  s_waitcnt lgkmcnt(4) vmcnt(3)
OC8:
  v_max3_u32 v2, v176, v177, v178
  v_max_u32 v2, v2, v179
  v_cmp_eq_u32 vcc, -1, v2
  s_cbranch_vccnz OR8
OK8:
  v_mfma_f32_32x32x16_bf16 v[32:47], v[76:79], v[176:179], v[32:47]
  ds_read_b64_tr_b16 v[76:77], v25 offset:10240
  ds_read_b64_tr_b16 v[78:79], v25 offset:11264
  s_waitcnt lgkmcnt(4)
  v_mfma_f32_32x32x16_bf16 v[48:63], v[68:71], v[176:179], v[48:63]
  ds_read_b64_tr_b16 v[68:69], v24 offset:12288
  ds_read_b64_tr_b16 v[70:71], v24 offset:13312
  s_waitcnt lgkmcnt(4) vmcnt(2)
OC10:
  v_max3_u32 v2, v180, v181, v182
  v_max_u32 v2, v2, v183
  v_cmp_eq_u32 vcc, -1, v2
  s_cbranch_vccnz OR10
OK10:
  v_mfma_f32_32x32x16_bf16 v[32:47], v[72:75], v[180:183], v[32:47]
  ds_read_b64_tr_b16 v[72:73], v25 offset:12288
  ds_read_b64_tr_b16 v[74:75], v25 offset:13312
  s_waitcnt lgkmcnt(4)
  v_mfma_f32_32x32x16_bf16 v[48:63], v[76:79], v[180:183], v[48:63]
  ds_read_b64_tr_b16 v[76:77], v24 offset:14336
  ds_read_b64_tr_b16 v[78:79], v24 offset:15360
  s_waitcnt lgkmcnt(4) vmcnt(1)
OC12:
  v_max3_u32 v2, v184, v185, v186
  v_max_u32 v2, v2, v187
  v_cmp_eq_u32 vcc, -1, v2
  s_cbranch_vccnz OR12
OK12:
  v_mfma_f32_32x32x16_bf16 v[32:47], v[68:71], v[184:187], v[32:47]
  ds_read_b64_tr_b16 v[68:69], v25 offset:14336
  ds_read_b64_tr_b16 v[70:71], v25 offset:15360
  s_waitcnt lgkmcnt(4)
  v_mfma_f32_32x32x16_bf16 v[48:63], v[72:75], v[184:187], v[48:63]
  s_waitcnt lgkmcnt(2) vmcnt(0)
OC14:
  v_max3_u32 v2, v188, v189, v190
  v_max_u32 v2, v2, v191
  v_cmp_eq_u32 vcc, -1, v2
  s_cbranch_vccnz OR14
OK14:
  v_mfma_f32_32x32x16_bf16 v[32:47], v[76:79], v[188:191], v[32:47]
  s_waitcnt lgkmcnt(0)
  v_mfma_f32_32x32x16_bf16 v[48:63], v[68:71], v[188:191], v[48:63]
  s_nop 7
  s_nop 1
  v_cvt_pk_bf16_f32 v96, v32, v33
  v_cvt_pk_bf16_f32 v97, v34, v35
  v_cvt_pk_bf16_f32 v98, v36, v37
  v_cvt_pk_bf16_f32 v99, v38, v39
  v_cvt_pk_bf16_f32 v100, v40, v41
  v_cvt_pk_bf16_f32 v101, v42, v43
  v_cvt_pk_bf16_f32 v102, v44, v45
  v_cvt_pk_bf16_f32 v103, v46, v47
  v_cvt_pk_bf16_f32 v104, v48, v49
  v_cvt_pk_bf16_f32 v105, v50, v51
  v_cvt_pk_bf16_f32 v106, v52, v53
  v_cvt_pk_bf16_f32 v107, v54, v55
  v_cvt_pk_bf16_f32 v108, v56, v57
  v_cvt_pk_bf16_f32 v109, v58, v59
  v_cvt_pk_bf16_f32 v110, v60, v61
  v_cvt_pk_bf16_f32 v111, v62, v63
  ds_write_b128 v27, v[96:99] offset:1024
  ds_write_b128 v27, v[100:103] offset:9216
  ds_write_b128 v27, v[104:107] offset:17408
  ds_write_b128 v27, v[108:111] offset:25600
  s_waitcnt lgkmcnt(0)
  s_barrier
  ds_read_b128 v[128:131], v28 offset:1024
  ds_read_b128 v[132:135], v28 offset:3072
  ds_read_b128 v[136:139], v28 offset:5120
  ds_read_b128 v[140:143], v28 offset:7168
  s_waitcnt lgkmcnt(3)
  v_lshlrev_b32 v96, 16, v128
  v_and_b32 v97, 0xffff0000, v128
  v_lshlrev_b32 v98, 16, v129
  v_and_b32 v99, 0xffff0000, v129
  v_lshlrev_b32 v100, 16, v130
  v_and_b32 v101, 0xffff0000, v130
  v_lshlrev_b32 v102, 16, v131
  v_and_b32 v103, 0xffff0000, v131
  s_waitcnt lgkmcnt(2)
  v_lshlrev_b32 v104, 16, v132
  v_and_b32 v105, 0xffff0000, v132
  v_lshlrev_b32 v106, 16, v133
  v_and_b32 v107, 0xffff0000, v133
  v_lshlrev_b32 v108, 16, v134
  v_and_b32 v109, 0xffff0000, v134
  v_lshlrev_b32 v110, 16, v135
  v_and_b32 v111, 0xffff0000, v135
  v_pk_add_f32 v[96:97], v[96:97], v[104:105]
  v_pk_add_f32 v[98:99], v[98:99], v[106:107]
  v_pk_add_f32 v[100:101], v[100:101], v[108:109]
  v_pk_add_f32 v[102:103], v[102:103], v[110:111]
  s_waitcnt lgkmcnt(1)
  v_lshlrev_b32 v112, 16, v136
  v_and_b32 v113, 0xffff0000, v136
  v_lshlrev_b32 v114, 16, v137
  v_and_b32 v115, 0xffff0000, v137
  v_lshlrev_b32 v116, 16, v138
  v_and_b32 v117, 0xffff0000, v138
  v_lshlrev_b32 v118, 16, v139
  v_and_b32 v119, 0xffff0000, v139
  v_pk_add_f32 v[96:97], v[96:97], v[112:113]
  v_pk_add_f32 v[98:99], v[98:99], v[114:115]
  v_pk_add_f32 v[100:101], v[100:101], v[116:117]
  v_pk_add_f32 v[102:103], v[102:103], v[118:119]
  s_waitcnt lgkmcnt(0)
  v_lshlrev_b32 v120, 16, v140
  v_and_b32 v121, 0xffff0000, v140
  v_lshlrev_b32 v122, 16, v141
  v_and_b32 v123, 0xffff0000, v141
  v_lshlrev_b32 v124, 16, v142
  v_and_b32 v125, 0xffff0000, v142
  v_lshlrev_b32 v126, 16, v143
  v_and_b32 v127, 0xffff0000, v143
  v_pk_add_f32 v[96:97], v[96:97], v[120:121]
  v_pk_add_f32 v[98:99], v[98:99], v[122:123]
  v_pk_add_f32 v[100:101], v[100:101], v[124:125]
  v_pk_add_f32 v[102:103], v[102:103], v[126:127]
  v_cvt_pk_bf16_f32 v16, v96, v97
  v_cvt_pk_bf16_f32 v17, v98, v99
  v_cvt_pk_bf16_f32 v18, v100, v101
  v_cvt_pk_bf16_f32 v19, v102, v103
  s_nop 1
  v_permlane32_swap_b32 v16, v18
  v_permlane32_swap_b32 v17, v19
  buffer_store_dwordx4 v[16:19], v14, s[48:51], s63 offen offset:0 nt
K_END:
  s_endpgm
OR0:
  s_add_u32 s97, s97, 1
  s_cmp_ge_u32 s97, 0x40000
  s_cbranch_scc1 OK0
  s_add_u32 s27, s29, 0
  buffer_load_dwordx4 v[160:163], v13, s[56:59], s27 offen offset:0 sc1
  buffer_load_dwordx4 v[164:167], v13, s[56:59], s27 offen offset:1024 sc1
  buffer_load_dwordx4 v[168:171], v13, s[56:59], s27 offen offset:2048 sc1
  buffer_load_dwordx4 v[172:175], v13, s[56:59], s27 offen offset:3072 sc1
  s_add_u32 s27, s29, 4096
  buffer_load_dwordx4 v[176:179], v13, s[56:59], s27 offen offset:0 sc1
  buffer_load_dwordx4 v[180:183], v13, s[56:59], s27 offen offset:1024 sc1
  buffer_load_dwordx4 v[184:187], v13, s[56:59], s27 offen offset:2048 sc1
  buffer_load_dwordx4 v[188:191], v13, s[56:59], s27 offen offset:3072 sc1
  s_waitcnt vmcnt(7)
  s_branch OC0
OR2:
  s_add_u32 s97, s97, 1
  s_cmp_ge_u32 s97, 0x40000
  s_cbranch_scc1 OK2
  s_add_u32 s27, s29, 0
  buffer_load_dwordx4 v[164:167], v13, s[56:59], s27 offen offset:1024 sc1
  buffer_load_dwordx4 v[168:171], v13, s[56:59], s27 offen offset:2048 sc1
  buffer_load_dwordx4 v[172:175], v13, s[56:59], s27 offen offset:3072 sc1
  s_add_u32 s27, s29, 4096
  buffer_load_dwordx4 v[176:179], v13, s[56:59], s27 offen offset:0 sc1
  buffer_load_dwordx4 v[180:183], v13, s[56:59], s27 offen offset:1024 sc1
  buffer_load_dwordx4 v[184:187], v13, s[56:59], s27 offen offset:2048 sc1
  buffer_load_dwordx4 v[188:191], v13, s[56:59], s27 offen offset:3072 sc1
  s_waitcnt vmcnt(6)
  s_branch OC2
OR4:
  s_add_u32 s97, s97, 1
  s_cmp_ge_u32 s97, 0x40000
  s_cbranch_scc1 OK4
  s_add_u32 s27, s29, 0
  buffer_load_dwordx4 v[168:171], v13, s[56:59], s27 offen offset:2048 sc1
  buffer_load_dwordx4 v[172:175], v13, s[56:59], s27 offen offset:3072 sc1
  s_add_u32 s27, s29, 4096
  buffer_load_dwordx4 v[176:179], v13, s[56:59], s27 offen offset:0 sc1
  buffer_load_dwordx4 v[180:183], v13, s[56:59], s27 offen offset:1024 sc1
  buffer_load_dwordx4 v[184:187], v13, s[56:59], s27 offen offset:2048 sc1
  buffer_load_dwordx4 v[188:191], v13, s[56:59], s27 offen offset:3072 sc1
  s_waitcnt vmcnt(5)
  s_branch OC4
OR6:
  s_add_u32 s97, s97, 1
  s_cmp_ge_u32 s97, 0x40000
  s_cbranch_scc1 OK6
  s_add_u32 s27, s29, 0
  buffer_load_dwordx4 v[172:175], v13, s[56:59], s27 offen offset:3072 sc1
  s_add_u32 s27, s29, 4096
  buffer_load_dwordx4 v[176:179], v13, s[56:59], s27 offen offset:0 sc1
  buffer_load_dwordx4 v[180:183], v13, s[56:59], s27 offen offset:1024 sc1
  buffer_load_dwordx4 v[184:187], v13, s[56:59], s27 offen offset:2048 sc1
  buffer_load_dwordx4 v[188:191], v13, s[56:59], s27 offen offset:3072 sc1
  s_waitcnt vmcnt(4)
  s_branch OC6
OR8:
  s_add_u32 s97, s97, 1
  s_cmp_ge_u32 s97, 0x40000
  s_cbranch_scc1 OK8
  s_add_u32 s27, s29, 4096
  buffer_load_dwordx4 v[176:179], v13, s[56:59], s27 offen offset:0 sc1
  buffer_load_dwordx4 v[180:183], v13, s[56:59], s27 offen offset:1024 sc1
  buffer_load_dwordx4 v[184:187], v13, s[56:59], s27 offen offset:2048 sc1
  buffer_load_dwordx4 v[188:191], v13, s[56:59], s27 offen offset:3072 sc1
  s_waitcnt vmcnt(3)
  s_branch OC8
OR10:
  s_add_u32 s97, s97, 1
  s_cmp_ge_u32 s97, 0x40000
  s_cbranch_scc1 OK10
  s_add_u32 s27, s29, 4096
  buffer_load_dwordx4 v[180:183], v13, s[56:59], s27 offen offset:1024 sc1
  buffer_load_dwordx4 v[184:187], v13, s[56:59], s27 offen offset:2048 sc1
  buffer_load_dwordx4 v[188:191], v13, s[56:59], s27 offen offset:3072 sc1
  s_waitcnt vmcnt(2)
  s_branch OC10
OR12:
  s_add_u32 s97, s97, 1
  s_cmp_ge_u32 s97, 0x40000
  s_cbranch_scc1 OK12
  s_add_u32 s27, s29, 4096
  buffer_load_dwordx4 v[184:187], v13, s[56:59], s27 offen offset:2048 sc1
  buffer_load_dwordx4 v[188:191], v13, s[56:59], s27 offen offset:3072 sc1
  s_waitcnt vmcnt(1)
  s_branch OC12
OR14:
  s_add_u32 s97, s97, 1
  s_cmp_ge_u32 s97, 0x40000
  s_cbranch_scc1 OK14
  s_add_u32 s27, s29, 4096
  buffer_load_dwordx4 v[188:191], v13, s[56:59], s27 offen offset:3072 sc1
  s_waitcnt vmcnt(0)
  s_branch OC14
K2_MAX:
  s_mov_b32 s27, 4194304
  v_mov_b32 v4, 0xff800000
K2_MAXL:
  buffer_load_dwordx4 v[84:87], v13, s[56:59], s27 offen sc1
  s_waitcnt vmcnt(0)
  v_mfma_f32_32x32x16_bf16 v[32:47], v[84:87], v[80:83], 0
  s_nop 7
  s_nop 4
  v_max3_f32 v4, v4, v32, v33
  v_max3_f32 v4, v4, v34, v35
  v_max3_f32 v4, v4, v36, v37
  v_max3_f32 v4, v4, v38, v39
  v_max3_f32 v4, v4, v40, v41
  v_max3_f32 v4, v4, v42, v43
  v_max3_f32 v4, v4, v44, v45
  v_max3_f32 v4, v4, v46, v47
  s_add_u32 s27, s27, 1024
  s_cmp_lt_u32 s27, 4259840
  s_cbranch_scc1 K2_MAXL
  v_mov_b32 v2, v4
  s_nop 1
  v_permlane32_swap_b32 v2, v4
  s_nop 1
  v_max_f32 v4, v2, v4
  v_subrev_u32 v2, 65536, v10
  v_mov_b32 v8, 0x3f803f80
  s_mov_b32 s27, 4194304
  v_sub_f32 v16, 0, v4
  v_mov_b32 v48, 0
  v_sub_f32 v17, 0, v4
  v_mov_b32 v49, 0
  v_sub_f32 v18, 0, v4
  v_mov_b32 v50, 0
  v_sub_f32 v19, 0, v4
  v_mov_b32 v51, 0
  v_sub_f32 v20, 0, v4
  v_mov_b32 v52, 0
  v_sub_f32 v21, 0, v4
  v_mov_b32 v53, 0
  v_sub_f32 v22, 0, v4
  v_mov_b32 v54, 0
  v_sub_f32 v23, 0, v4
  v_mov_b32 v55, 0
  v_sub_f32 v24, 0, v4
  v_mov_b32 v56, 0
  v_sub_f32 v25, 0, v4
  v_mov_b32 v57, 0
  v_sub_f32 v26, 0, v4
  v_mov_b32 v58, 0
  v_sub_f32 v27, 0, v4
  v_mov_b32 v59, 0
  v_sub_f32 v28, 0, v4
  v_mov_b32 v60, 0
  v_sub_f32 v29, 0, v4
  v_mov_b32 v61, 0
  v_sub_f32 v30, 0, v4
  v_mov_b32 v62, 0
  v_sub_f32 v31, 0, v4
  v_mov_b32 v63, 0
K2_SUML:
  s_add_u32 s35, s27, 65536
  buffer_load_dwordx4 v[84:87], v13, s[56:59], s27 offen sc1
  buffer_load_dwordx4 v[88:91], v2, s[56:59], s35 offen sc1
  buffer_load_dwordx4 v[92:95], v2, s[56:59], s35 offen offset:512 sc1
  s_waitcnt vmcnt(0)
  v_mfma_f32_32x32x16_bf16 v[32:47], v[84:87], v[80:83], v[16:31]
  v_cndmask_b32 v88, v88, v8, s[70:71]
  v_cndmask_b32 v89, v89, v8, s[70:71]
  v_cndmask_b32 v90, v90, v8, s[70:71]
  v_cndmask_b32 v91, v91, v8, s[70:71]
  v_cndmask_b32 v92, v92, v8, s[70:71]
  v_cndmask_b32 v93, v93, v8, s[70:71]
  v_cndmask_b32 v94, v94, v8, s[70:71]
  v_cndmask_b32 v95, v95, v8, s[70:71]
  s_nop 4
  v_exp_f32 v32, v32
  v_exp_f32 v33, v33
  v_exp_f32 v34, v34
  v_exp_f32 v35, v35
  v_exp_f32 v36, v36
  v_exp_f32 v37, v37
  v_exp_f32 v38, v38
  v_exp_f32 v39, v39
  v_exp_f32 v40, v40
  v_exp_f32 v41, v41
  v_exp_f32 v42, v42
  v_exp_f32 v43, v43
  v_exp_f32 v44, v44
  v_exp_f32 v45, v45
  v_exp_f32 v46, v46
  v_exp_f32 v47, v47
  s_nop 1
  v_smfmac_f32_32x32x32_bf16 v[48:63], v[88:91], v[32:39], v15
  v_smfmac_f32_32x32x32_bf16 v[48:63], v[92:95], v[40:47], v15
  s_add_u32 s27, s27, 1024
  s_cmp_lt_u32 s27, 4259840
  s_nop 7
  s_nop 4
  s_cbranch_scc1 K2_SUML
  s_branch K2_FIN
.section .rodata,"a"
.p2align 6
.amdhsa_kernel concat_heads__grouped_kv_mqa__linear_kernel_hedgehog__prompt_kernel
  .amdhsa_next_free_vgpr 256
  .amdhsa_next_free_sgpr 100
  .amdhsa_accum_offset 256
  .amdhsa_group_segment_fixed_size 0
  .amdhsa_kernarg_size 96
  .amdhsa_user_sgpr_count 2
  .amdhsa_user_sgpr_kernarg_segment_ptr 1
  .amdhsa_system_sgpr_workgroup_id_x 1
.end_amdhsa_kernel
```
